```python
import torch

def _softmax(x, axis=-1):
    return torch.softmax(x, dim=axis)
def _gelu(x):
    return torch.nn.functional.gelu(x, approximate="tanh")
def _silu(x):
    return torch.nn.functional.silu(x)
def _sigmoid(x):
    return torch.sigmoid(x)
def _layernorm(x, axis=-1, eps=1e-5):
    m = x.mean(dim=axis, keepdim=True)
    v = x.var(dim=axis, keepdim=True, unbiased=False)
    return (x - m) / torch.sqrt(v + eps)
def _scatter_add(tgt, idx, src, axis=0):
    return tgt.clone().index_add_(axis, idx, src)
def _segment_sum(src, seg, n):
    out = torch.zeros((n,) + src.shape[1:], dtype=src.dtype)
    return out.index_add_(0, seg, src)
def _pad(x, pw):
    flat = tuple(v for pair in reversed(pw) for v in pair)
    return torch.nn.functional.pad(x, flat)

kernel_name = 'parallel_sum__ssm_conv_s4d__mixer_token_mlp__prompt'

def setup_inputs():

    _w = (lambda a: (lambda t: t.to(torch.bfloat16) if t.is_floating_point() else t)(torch.as_tensor(a)))
    def _A_setup():
        Bsz, L, D, N = 1, 2048, 576, 128
        return {
            "u": _w((lambda *s: torch.randn(*s, dtype=torch.bfloat16) * 0.05)(Bsz, L, D)),
            "log_A_real": _w((lambda *s: torch.randn(*s, dtype=torch.bfloat16) * 6.4)(D, N) * 0.5),
            "A_imag": _w((lambda *s: torch.randn(*s, dtype=torch.bfloat16) * 0.05)(D, N) * 3.14),
            "C_real": _w((lambda *s: torch.randn(*s, dtype=torch.bfloat16) * 0.05)(D, N) / N ** 0.5),
            "C_imag": _w((lambda *s: torch.randn(*s, dtype=torch.bfloat16) * 0.1)(D, N) / N ** 0.5),
            "log_dt": _w((lambda *s: torch.randn(*s, dtype=torch.bfloat16) * 0.05)(D) * 0.5 - 4.0),
            "D_skip": _w((lambda *s: torch.randn(*s, dtype=torch.bfloat16) * 0.05)(D)),
        }
    _A_in = _A_setup()

    def _B_setup():
        B, S, D, F = 1, 2048, 576, 4608
        return {
            "x": _w((lambda *s: torch.randn(*s, dtype=torch.bfloat16) * 0.05)(B, S, D)),
            "w1": _w((lambda *s: torch.randn(*s, dtype=torch.bfloat16) * 0.8)(S, F) * (S ** -0.5)),
            "b1": _w((lambda *s: torch.randn(*s, dtype=torch.bfloat16) * 12.8)(F) * 0.02),
            "w2": _w((lambda *s: torch.randn(*s, dtype=torch.bfloat16) * 0.2)(F, S) * (F ** -0.5)),
            "b2": _w((lambda *s: torch.randn(*s, dtype=torch.bfloat16) * 1.6)(S) * 0.02),
        }
    _B_in = _B_setup()

    return {
        "A_u": _A_in["u"],
        "A_log_A_real": _A_in["log_A_real"],
        "A_A_imag": _A_in["A_imag"],
        "A_C_real": _A_in["C_real"],
        "A_C_imag": _A_in["C_imag"],
        "A_log_dt": _A_in["log_dt"],
        "A_D_skip": _A_in["D_skip"],
        "B_x": _B_in["x"],
        "B_w1": _B_in["w1"],
        "B_b1": _B_in["b1"],
        "B_w2": _B_in["w2"],
        "B_b2": _B_in["b2"],
    }

def reference(A_u, A_log_A_real, A_A_imag, A_C_real, A_C_imag, A_log_dt, A_D_skip, B_x, B_w1, B_b1, B_w2, B_b2):
    def _A_ref(u, log_A_real, A_imag, C_real, C_imag, log_dt, D_skip):
        L = u.shape[1]
        dt = torch.exp(log_dt)
        A = -torch.exp(log_A_real) + 1j * A_imag
        C = (C_real + 1j * C_imag) * dt[:, None]
        pos = (lambda x, dt: x.to(dt))(torch.arange(L), log_dt.dtype)
        P = torch.exp((A * dt[:, None])[:, :, None] * pos[None, None, :])
        K = 2.0 * torch.einsum("dn,dnl->dl", C, P).real
        L2 = 2 * L
        u_t = (lambda x, *d: x.permute(*d))(u, 0, 2, 1)
        Kf = (lambda x, *a, **k: torch.fft.rfft(x.float(), *a, **k))(K, L2)
        Uf = (lambda x, *a, **k: torch.fft.rfft(x.float(), *a, **k))(u_t, L2)
        y = (lambda x, *a, **k: torch.fft.irfft(x, *a, **k).to(torch.bfloat16))(Uf * Kf[None, :, :], L2)[:, :, :L]
        y = (lambda x, *d: x.permute(*d))(y, 0, 2, 1)
        return y + u * D_skip[None, None, :]

    def _B_ref(x, w1, b1, w2, b2):
        B, S, D = x.shape
        h = _layernorm(x, axis=-1)
        u = torch.einsum("bsd,sf->bdf", h, w1) + b1
        u = _gelu(u)
        y = torch.einsum("bdf,fs->bds", u, w2) + b2
        return (lambda x, *d: x.permute(*d))(y, 0, 2, 1)

    x = A_u
    xn = _layernorm(x, axis=-1)
    return x + _A_ref(xn, A_log_A_real, A_A_imag, A_C_real, A_C_imag, A_log_dt, A_D_skip) + _B_ref(xn, B_w1, B_b1, B_w2, B_b2)
```

```asm
; @launch grid=(256,1,1) block=(320,1,1) lds=158784
.amdgcn_target "amdgcn-amd-amdhsa--gfx950"
.text
.globl parallel_sum__ssm_conv_s4d__mixer_token_mlp__prompt_kernel
.p2align 8
.type parallel_sum__ssm_conv_s4d__mixer_token_mlp__prompt_kernel,@function
parallel_sum__ssm_conv_s4d__mixer_token_mlp__prompt_kernel:
L_m_base:
  s_cmp_ge_u32 s2, 256
  s_cbranch_scc1 L_m_end
  s_load_dwordx2 s[6:7], s[0:1], 0
  s_load_dwordx2 s[4:5], s[0:1], 112
  s_load_dwordx2 s[96:97], s[0:1], 64
  s_load_dwordx2 s[98:99], s[0:1], 80
  v_lshrrev_b32 v1, 6, v0
  s_nop 0
  v_readfirstlane_b32 s20, v1
  v_and_b32 v1, 63, v0
  s_cmp_lg_u32 s20, 0
  s_cbranch_scc1 L_m_nocode
  s_getpc_b64 s[12:13]
L_m_pc:
  s_sub_u32 s12, s12, L_m_pc-L_m_base
  s_subb_u32 s13, s13, 0
  s_mov_b32 s14, L_m_last-L_m_base
  s_mov_b32 s15, 0x20000
  v_lshlrev_b32 v4, 4, v1
  s_lshr_b32 s23, s2, 3
  s_lshl_b32 s23, s23, 10
  buffer_load_dwordx4 v[96:99], v4, s[12:15], s23 offen
  s_add_u32 s23, s23, 32768
  buffer_load_dwordx4 v[96:99], v4, s[12:15], s23 offen
  s_add_u32 s23, s23, 32768
L_m_nocode:
  s_cmp_eq_u32 s20, 4
  s_cbranch_scc1 L_m_w4
  s_waitcnt lgkmcnt(0)
  s_mov_b32 s8, s6
  s_mov_b32 s9, s7
  s_mov_b32 s10, 0x240000
  s_mov_b32 s11, 0x20000
  s_lshl_b32 s22, s2, 2
  s_add_u32 s22, s22, s20
  s_mul_i32 s22, s22, 2304
  v_lshrrev_b32 v4, 5, v1
  v_and_b32 v5, 31, v1
  v_mul_u32_u24 v6, 1152, v4
  v_lshl_add_u32 v2, v5, 4, v6
  v_lshl_add_u32 v3, v5, 2, v6
  buffer_load_dwordx4 v[10:13], v2, s[8:11], s22 offen nt
  buffer_load_dwordx4 v[14:17], v2, s[8:11], s22 offen offset:512 nt
  buffer_load_dword v18, v3, s[8:11], s22 offen offset:1024 nt
  s_add_u32 s26, s4, 0xff00
  s_addc_u32 s27, s5, 0
  s_load_dword s101, s[26:27], 0
  s_cmp_lg_u32 s20, 0
  s_cbranch_scc1 L_m_nz
  v_mov_b32 v58, 158720
  v_mov_b32 v60, 0
  v_mov_b32 v61, 0
  v_mov_b32 v62, 0
  v_mov_b32 v63, 0
  ds_write_b128 v58, v[60:63]
L_m_nz:
  s_load_dwordx2 s[38:39], s[0:1], 72
  s_load_dwordx8 s[80:87], s[0:1], 8
  s_load_dwordx4 s[88:91], s[0:1], 40
  s_add_u32 s12, s4, 0x40000
  s_addc_u32 s13, s5, 0
  s_mov_b32 s14, 0x240000
  s_mov_b32 s15, 0x20000
  s_add_u32 s16, s4, 0x280000
  s_addc_u32 s17, s5, 0
  s_mov_b32 s18, 0x240000
  s_mov_b32 s19, 0x20000
  s_mul_i32 s23, s20, 2432
  s_add_u32 s23, s23, 139264
  v_mul_u32_u24 v6, 1216, v4
  v_add_u32 v6, s23, v6
  v_lshl_add_u32 v2, v5, 4, v6
  v_lshl_add_u32 v3, v5, 2, v6
  v_and_b32 v5, 15, v1
  v_lshrrev_b32 v6, 4, v1
  v_bfe_u32 v7, v1, 2, 2
  v_and_b32 v8, 3, v1
  v_mul_u32_u24 v7, 1216, v7
  v_lshl_add_u32 v7, v8, 3, v7
  v_lshl_add_u32 v7, v6, 5, v7
  s_lshl_b32 s23, s20, 7
  s_add_u32 s23, s23, 139264
  v_add_u32 v7, s23, v7
  v_lshlrev_b32 v9, 16, v6
  v_lshl_add_u32 v9, v5, 4, v9
  s_lshl_b32 s22, s20, 18
  s_lshl_b32 s23, s2, 8
  s_add_u32 s22, s22, s23
  v_lshlrev_b32 v19, 11, v6
  v_lshl_add_u32 v19, v5, 4, v19
  s_lshr_b32 s25, s2, 3
  s_mul_i32 s25, s25, 73728
  s_and_b32 s23, s2, 7
  s_lshl_b32 s23, s23, 8
  s_add_u32 s21, s25, s23
  s_lshl_b32 s23, s20, 13
  s_add_u32 s25, s21, s23
  s_waitcnt vmcnt(0)
  v_lshlrev_b32 v20, 16, v10
  v_and_b32 v21, 0xffff0000, v10
  v_lshlrev_b32 v22, 16, v11
  v_and_b32 v23, 0xffff0000, v11
  v_lshlrev_b32 v24, 16, v12
  v_and_b32 v25, 0xffff0000, v12
  v_lshlrev_b32 v26, 16, v13
  v_and_b32 v27, 0xffff0000, v13
  v_lshlrev_b32 v28, 16, v14
  v_and_b32 v29, 0xffff0000, v14
  v_lshlrev_b32 v30, 16, v15
  v_and_b32 v31, 0xffff0000, v15
  v_lshlrev_b32 v32, 16, v16
  v_and_b32 v33, 0xffff0000, v16
  v_lshlrev_b32 v34, 16, v17
  v_and_b32 v35, 0xffff0000, v17
  v_lshlrev_b32 v36, 16, v18
  v_and_b32 v37, 0xffff0000, v18
  v_pk_add_f32 v[40:41], v[20:21], v[22:23]
  v_pk_add_f32 v[42:43], v[24:25], v[26:27]
  v_pk_add_f32 v[44:45], v[28:29], v[30:31]
  v_pk_add_f32 v[46:47], v[32:33], v[34:35]
  v_pk_add_f32 v[40:41], v[40:41], v[42:43]
  v_pk_add_f32 v[44:45], v[44:45], v[46:47]
  v_pk_add_f32 v[40:41], v[40:41], v[36:37]
  v_pk_add_f32 v[40:41], v[40:41], v[44:45]
  v_add_f32 v58, v40, v41
  s_nop 1
  v_add_f32_dpp v58, v58, v58 row_ror:1 row_mask:0xf bank_mask:0xf
  s_nop 1
  v_add_f32_dpp v58, v58, v58 row_ror:2 row_mask:0xf bank_mask:0xf
  s_nop 1
  v_add_f32_dpp v58, v58, v58 row_ror:4 row_mask:0xf bank_mask:0xf
  s_nop 1
  v_add_f32_dpp v58, v58, v58 row_ror:8 row_mask:0xf bank_mask:0xf
  v_mov_b32 v59, v58
  s_nop 1
  v_permlane16_swap_b32 v59, v58
  v_add_f32 v58, v58, v59
  v_mul_f32 v60, 0x3ae38e39, v58
  v_pk_add_f32 v[40:41], v[20:21], v[60:61] op_sel_hi:[1,0] neg_lo:[0,1] neg_hi:[0,1]
  v_pk_add_f32 v[42:43], v[22:23], v[60:61] op_sel_hi:[1,0] neg_lo:[0,1] neg_hi:[0,1]
  v_pk_add_f32 v[44:45], v[24:25], v[60:61] op_sel_hi:[1,0] neg_lo:[0,1] neg_hi:[0,1]
  v_pk_add_f32 v[46:47], v[26:27], v[60:61] op_sel_hi:[1,0] neg_lo:[0,1] neg_hi:[0,1]
  v_pk_add_f32 v[48:49], v[28:29], v[60:61] op_sel_hi:[1,0] neg_lo:[0,1] neg_hi:[0,1]
  v_pk_add_f32 v[50:51], v[30:31], v[60:61] op_sel_hi:[1,0] neg_lo:[0,1] neg_hi:[0,1]
  v_pk_add_f32 v[52:53], v[32:33], v[60:61] op_sel_hi:[1,0] neg_lo:[0,1] neg_hi:[0,1]
  v_pk_add_f32 v[54:55], v[34:35], v[60:61] op_sel_hi:[1,0] neg_lo:[0,1] neg_hi:[0,1]
  v_pk_add_f32 v[56:57], v[36:37], v[60:61] op_sel_hi:[1,0] neg_lo:[0,1] neg_hi:[0,1]
  v_pk_mul_f32 v[58:59], v[40:41], v[40:41]
  v_pk_mul_f32 v[62:63], v[42:43], v[42:43]
  v_pk_fma_f32 v[58:59], v[44:45], v[44:45], v[58:59]
  v_pk_fma_f32 v[62:63], v[46:47], v[46:47], v[62:63]
  v_pk_fma_f32 v[58:59], v[48:49], v[48:49], v[58:59]
  v_pk_fma_f32 v[62:63], v[50:51], v[50:51], v[62:63]
  v_pk_fma_f32 v[58:59], v[52:53], v[52:53], v[58:59]
  v_pk_fma_f32 v[62:63], v[54:55], v[54:55], v[62:63]
  v_pk_fma_f32 v[58:59], v[56:57], v[56:57], v[58:59]
  v_pk_add_f32 v[58:59], v[58:59], v[62:63]
  v_add_f32 v58, v58, v59
  v_cvt_pk_bf16_f32 v60, v60, v60
  v_lshlrev_b32 v60, 16, v60
  v_add_f32_dpp v58, v58, v58 row_ror:1 row_mask:0xf bank_mask:0xf
  v_pk_add_f32 v[40:41], v[20:21], v[60:61] op_sel_hi:[1,0] neg_lo:[0,1] neg_hi:[0,1]
  v_pk_add_f32 v[42:43], v[22:23], v[60:61] op_sel_hi:[1,0] neg_lo:[0,1] neg_hi:[0,1]
  v_add_f32_dpp v58, v58, v58 row_ror:2 row_mask:0xf bank_mask:0xf
  v_pk_add_f32 v[44:45], v[24:25], v[60:61] op_sel_hi:[1,0] neg_lo:[0,1] neg_hi:[0,1]
  v_pk_add_f32 v[46:47], v[26:27], v[60:61] op_sel_hi:[1,0] neg_lo:[0,1] neg_hi:[0,1]
  v_add_f32_dpp v58, v58, v58 row_ror:4 row_mask:0xf bank_mask:0xf
  v_pk_add_f32 v[48:49], v[28:29], v[60:61] op_sel_hi:[1,0] neg_lo:[0,1] neg_hi:[0,1]
  v_pk_add_f32 v[50:51], v[30:31], v[60:61] op_sel_hi:[1,0] neg_lo:[0,1] neg_hi:[0,1]
  v_add_f32_dpp v58, v58, v58 row_ror:8 row_mask:0xf bank_mask:0xf
  v_mov_b32 v59, v58
  v_pk_add_f32 v[52:53], v[32:33], v[60:61] op_sel_hi:[1,0] neg_lo:[0,1] neg_hi:[0,1]
  v_pk_add_f32 v[54:55], v[34:35], v[60:61] op_sel_hi:[1,0] neg_lo:[0,1] neg_hi:[0,1]
  v_permlane16_swap_b32 v59, v58
  v_pk_add_f32 v[56:57], v[36:37], v[60:61] op_sel_hi:[1,0] neg_lo:[0,1] neg_hi:[0,1]
  v_add_f32 v58, v58, v59
  v_mul_f32 v62, 0x3ae38e39, v58
  v_cvt_pk_bf16_f32 v62, v62, v62
  v_lshlrev_b32 v62, 16, v62
  v_add_f32 v62, 0x3727c5ac, v62
  v_cvt_pk_bf16_f32 v62, v62, v62
  v_lshlrev_b32 v62, 16, v62
  v_sqrt_f32 v62, v62
  v_cvt_pk_bf16_f32 v10, v40, v41
  v_cvt_pk_bf16_f32 v11, v42, v43
  v_cvt_pk_bf16_f32 v12, v44, v45
  v_cvt_pk_bf16_f32 v13, v46, v47
  v_cvt_pk_bf16_f32 v62, v62, v62
  v_lshlrev_b32 v62, 16, v62
  v_rcp_f32 v62, v62
  v_cvt_pk_bf16_f32 v14, v48, v49
  v_cvt_pk_bf16_f32 v15, v50, v51
  v_cvt_pk_bf16_f32 v16, v52, v53
  v_cvt_pk_bf16_f32 v17, v54, v55
  v_cvt_pk_bf16_f32 v18, v56, v57
  v_lshlrev_b32 v20, 16, v10
  v_and_b32 v21, 0xffff0000, v10
  v_lshlrev_b32 v22, 16, v11
  v_and_b32 v23, 0xffff0000, v11
  v_lshlrev_b32 v24, 16, v12
  v_and_b32 v25, 0xffff0000, v12
  v_lshlrev_b32 v26, 16, v13
  v_and_b32 v27, 0xffff0000, v13
  v_lshlrev_b32 v28, 16, v14
  v_and_b32 v29, 0xffff0000, v14
  v_lshlrev_b32 v30, 16, v15
  v_and_b32 v31, 0xffff0000, v15
  v_lshlrev_b32 v32, 16, v16
  v_and_b32 v33, 0xffff0000, v16
  v_lshlrev_b32 v34, 16, v17
  v_and_b32 v35, 0xffff0000, v17
  v_lshlrev_b32 v36, 16, v18
  v_and_b32 v37, 0xffff0000, v18
  v_pk_mul_f32 v[20:21], v[20:21], v[62:63] op_sel_hi:[1,0]
  v_pk_mul_f32 v[22:23], v[22:23], v[62:63] op_sel_hi:[1,0]
  v_pk_mul_f32 v[24:25], v[24:25], v[62:63] op_sel_hi:[1,0]
  v_pk_mul_f32 v[26:27], v[26:27], v[62:63] op_sel_hi:[1,0]
  v_pk_mul_f32 v[28:29], v[28:29], v[62:63] op_sel_hi:[1,0]
  v_pk_mul_f32 v[30:31], v[30:31], v[62:63] op_sel_hi:[1,0]
  v_pk_mul_f32 v[32:33], v[32:33], v[62:63] op_sel_hi:[1,0]
  v_pk_mul_f32 v[34:35], v[34:35], v[62:63] op_sel_hi:[1,0]
  v_pk_mul_f32 v[36:37], v[36:37], v[62:63] op_sel_hi:[1,0]
  v_cvt_pk_bf16_f32 v10, v20, v21
  v_cvt_pk_bf16_f32 v11, v22, v23
  v_cvt_pk_bf16_f32 v12, v24, v25
  v_cvt_pk_bf16_f32 v13, v26, v27
  v_cvt_pk_bf16_f32 v14, v28, v29
  v_cvt_pk_bf16_f32 v15, v30, v31
  v_cvt_pk_bf16_f32 v16, v32, v33
  v_cvt_pk_bf16_f32 v17, v34, v35
  v_cvt_pk_bf16_f32 v18, v36, v37
  ds_write_b128 v2, v[10:13]
  ds_write_b128 v2, v[14:17] offset:512
  ds_write_b32 v3, v18 offset:1024
  v_lshlrev_b32 v20, 16, v10
  v_and_b32 v21, 0xffff0000, v10
  v_lshlrev_b32 v22, 16, v11
  v_and_b32 v23, 0xffff0000, v11
  v_lshlrev_b32 v24, 16, v12
  v_and_b32 v25, 0xffff0000, v12
  v_lshlrev_b32 v26, 16, v13
  v_and_b32 v27, 0xffff0000, v13
  v_lshlrev_b32 v28, 16, v14
  v_and_b32 v29, 0xffff0000, v14
  v_lshlrev_b32 v30, 16, v15
  v_and_b32 v31, 0xffff0000, v15
  v_lshlrev_b32 v32, 16, v16
  v_and_b32 v33, 0xffff0000, v16
  v_lshlrev_b32 v34, 16, v17
  v_and_b32 v35, 0xffff0000, v17
  v_lshlrev_b32 v36, 16, v18
  v_and_b32 v37, 0xffff0000, v18
  v_pk_add_f32 v[40:41], v[20:21], v[22:23]
  v_pk_add_f32 v[42:43], v[24:25], v[26:27]
  v_pk_add_f32 v[44:45], v[28:29], v[30:31]
  v_pk_add_f32 v[46:47], v[32:33], v[34:35]
  v_pk_add_f32 v[40:41], v[40:41], v[42:43]
  v_pk_add_f32 v[44:45], v[44:45], v[46:47]
  v_pk_add_f32 v[40:41], v[40:41], v[36:37]
  v_pk_add_f32 v[40:41], v[40:41], v[44:45]
  v_add_f32 v58, v40, v41
  v_pk_mul_f32 v[74:75], v[20:21], v[20:21]
  v_pk_mul_f32 v[62:63], v[22:23], v[22:23]
  v_add_f32_dpp v58, v58, v58 row_ror:1 row_mask:0xf bank_mask:0xf
  v_pk_fma_f32 v[74:75], v[24:25], v[24:25], v[74:75]
  v_pk_fma_f32 v[62:63], v[26:27], v[26:27], v[62:63]
  v_add_f32_dpp v58, v58, v58 row_ror:2 row_mask:0xf bank_mask:0xf
  v_pk_fma_f32 v[74:75], v[28:29], v[28:29], v[74:75]
  v_pk_fma_f32 v[62:63], v[30:31], v[30:31], v[62:63]
  v_add_f32_dpp v58, v58, v58 row_ror:4 row_mask:0xf bank_mask:0xf
  v_pk_fma_f32 v[74:75], v[32:33], v[32:33], v[74:75]
  v_pk_fma_f32 v[62:63], v[34:35], v[34:35], v[62:63]
  v_add_f32_dpp v58, v58, v58 row_ror:8 row_mask:0xf bank_mask:0xf
  v_pk_fma_f32 v[74:75], v[36:37], v[36:37], v[74:75]
  v_pk_add_f32 v[74:75], v[74:75], v[62:63]
  v_mov_b32 v59, v58
  v_add_f32 v74, v74, v75
  s_nop 0
  v_permlane16_swap_b32 v59, v58
  v_add_f32_dpp v74, v74, v74 row_ror:1 row_mask:0xf bank_mask:0xf
  v_add_f32 v58, v58, v59
  v_mul_f32 v76, 0x3ae38e39, v58
  v_add_f32_dpp v74, v74, v74 row_ror:2 row_mask:0xf bank_mask:0xf
  v_cvt_pk_bf16_f32 v60, v76, v76
  v_lshlrev_b32 v60, 16, v60
  v_add_f32_dpp v74, v74, v74 row_ror:4 row_mask:0xf bank_mask:0xf
  v_pk_add_f32 v[40:41], v[20:21], v[60:61] op_sel_hi:[1,0] neg_lo:[0,1] neg_hi:[0,1]
  v_pk_add_f32 v[42:43], v[22:23], v[60:61] op_sel_hi:[1,0] neg_lo:[0,1] neg_hi:[0,1]
  v_add_f32_dpp v74, v74, v74 row_ror:8 row_mask:0xf bank_mask:0xf
  v_mov_b32 v75, v74
  v_pk_add_f32 v[44:45], v[24:25], v[60:61] op_sel_hi:[1,0] neg_lo:[0,1] neg_hi:[0,1]
  v_pk_add_f32 v[46:47], v[26:27], v[60:61] op_sel_hi:[1,0] neg_lo:[0,1] neg_hi:[0,1]
  v_permlane16_swap_b32 v75, v74
  v_pk_add_f32 v[48:49], v[28:29], v[60:61] op_sel_hi:[1,0] neg_lo:[0,1] neg_hi:[0,1]
  v_pk_add_f32 v[50:51], v[30:31], v[60:61] op_sel_hi:[1,0] neg_lo:[0,1] neg_hi:[0,1]
  v_pk_add_f32 v[52:53], v[32:33], v[60:61] op_sel_hi:[1,0] neg_lo:[0,1] neg_hi:[0,1]
  v_pk_add_f32 v[54:55], v[34:35], v[60:61] op_sel_hi:[1,0] neg_lo:[0,1] neg_hi:[0,1]
  v_pk_add_f32 v[56:57], v[36:37], v[60:61] op_sel_hi:[1,0] neg_lo:[0,1] neg_hi:[0,1]
  v_add_f32 v74, v74, v75
  v_mul_f32 v76, v76, v76
  v_mov_b32 v62, 0x3ae38e39
  v_fma_f32 v62, v74, v62, -v76
  v_max_f32 v62, 0, v62
  v_cvt_pk_bf16_f32 v62, v62, v62
  v_lshlrev_b32 v62, 16, v62
  v_add_f32 v62, 0x3727c5ac, v62
  v_cvt_pk_bf16_f32 v62, v62, v62
  v_lshlrev_b32 v62, 16, v62
  v_sqrt_f32 v62, v62
  v_cvt_pk_bf16_f32 v64, v40, v41
  v_cvt_pk_bf16_f32 v65, v42, v43
  v_cvt_pk_bf16_f32 v66, v44, v45
  v_cvt_pk_bf16_f32 v67, v46, v47
  v_cvt_pk_bf16_f32 v62, v62, v62
  v_lshlrev_b32 v62, 16, v62
  v_rcp_f32 v62, v62
  v_cvt_pk_bf16_f32 v68, v48, v49
  v_cvt_pk_bf16_f32 v69, v50, v51
  v_cvt_pk_bf16_f32 v70, v52, v53
  v_cvt_pk_bf16_f32 v71, v54, v55
  v_cvt_pk_bf16_f32 v72, v56, v57
  v_lshlrev_b32 v20, 16, v64
  v_and_b32 v21, 0xffff0000, v64
  v_lshlrev_b32 v22, 16, v65
  v_and_b32 v23, 0xffff0000, v65
  v_lshlrev_b32 v24, 16, v66
  v_and_b32 v25, 0xffff0000, v66
  v_lshlrev_b32 v26, 16, v67
  v_and_b32 v27, 0xffff0000, v67
  v_lshlrev_b32 v28, 16, v68
  v_and_b32 v29, 0xffff0000, v68
  v_lshlrev_b32 v30, 16, v69
  v_and_b32 v31, 0xffff0000, v69
  v_lshlrev_b32 v32, 16, v70
  v_and_b32 v33, 0xffff0000, v70
  v_lshlrev_b32 v34, 16, v71
  v_and_b32 v35, 0xffff0000, v71
  v_lshlrev_b32 v36, 16, v72
  v_and_b32 v37, 0xffff0000, v72
  v_pk_mul_f32 v[20:21], v[20:21], v[62:63] op_sel_hi:[1,0]
  v_pk_mul_f32 v[22:23], v[22:23], v[62:63] op_sel_hi:[1,0]
  v_pk_mul_f32 v[24:25], v[24:25], v[62:63] op_sel_hi:[1,0]
  v_pk_mul_f32 v[26:27], v[26:27], v[62:63] op_sel_hi:[1,0]
  v_pk_mul_f32 v[28:29], v[28:29], v[62:63] op_sel_hi:[1,0]
  v_pk_mul_f32 v[30:31], v[30:31], v[62:63] op_sel_hi:[1,0]
  v_pk_mul_f32 v[32:33], v[32:33], v[62:63] op_sel_hi:[1,0]
  v_pk_mul_f32 v[34:35], v[34:35], v[62:63] op_sel_hi:[1,0]
  v_pk_mul_f32 v[36:37], v[36:37], v[62:63] op_sel_hi:[1,0]
  v_cvt_pk_bf16_f32 v64, v20, v21
  v_cvt_pk_bf16_f32 v65, v22, v23
  v_cvt_pk_bf16_f32 v66, v24, v25
  v_cvt_pk_bf16_f32 v67, v26, v27
  v_cvt_pk_bf16_f32 v68, v28, v29
  v_cvt_pk_bf16_f32 v69, v30, v31
  v_cvt_pk_bf16_f32 v70, v32, v33
  v_cvt_pk_bf16_f32 v71, v34, v35
  v_cvt_pk_bf16_f32 v72, v36, v37
  ds_write_b128 v2, v[64:67] offset:9728
  ds_write_b128 v2, v[68:71] offset:10240
  ds_write_b32 v3, v72 offset:10752
  s_waitcnt lgkmcnt(0)
  s_barrier
  ds_read_b64_tr_b16 v[28:29], v7 offset:9728
  ds_read_b64_tr_b16 v[30:31], v7 offset:14592
  ds_read_b64_tr_b16 v[24:25], v7 offset:0
  ds_read_b64_tr_b16 v[26:27], v7 offset:4864
  ds_read_b64_tr_b16 v[36:37], v7 offset:10240
  ds_read_b64_tr_b16 v[38:39], v7 offset:15104
  ds_read_b64_tr_b16 v[32:33], v7 offset:512
  ds_read_b64_tr_b16 v[34:35], v7 offset:5376
  s_cmp_ge_u32 s20, 2
  s_cbranch_scc1 L_ln_no8
  s_mul_i32 s23, s20, 9856
  s_sub_u32 s23, 10752, s23
  v_add_u32 v8, s23, v7
  ds_read_b64_tr_b16 v[40:41], v8
  ds_read_b64_tr_b16 v[42:43], v8 offset:4864
  s_waitcnt lgkmcnt(0)
  s_cmp_lg_u32 s20, 0
  s_cbranch_scc1 L_ln_no8
  s_add_u32 s23, s21, 65536
  buffer_store_dwordx4 v[40:43], v19, s[12:15], s23 offen sc1
L_ln_no8:
  s_waitcnt lgkmcnt(0)
  buffer_store_dwordx4 v[28:31], v19, s[12:15], s25 offen sc1
  s_add_u32 s25, s25, 32768
  buffer_store_dwordx4 v[36:39], v19, s[12:15], s25 offen sc1
  s_add_u32 s40, s4, 0x0
  s_addc_u32 s41, s5, 0
  s_mov_b32 s42, 0x40000
  s_mov_b32 s43, 0x20000
  s_mul_i32 s101, s101, 0x9e3779b1
  s_add_u32 s101, s101, 0x7f4a7c15
  s_andn2_b32 s100, s101, 0xff
  v_mov_b32 v61, 0
  s_cmp_lg_u32 s20, 3
  s_cbranch_scc1 L_m_nozero
  s_sub_u32 s23, s2, 28
  s_cmp_ge_u32 s23, 6
  s_cbranch_scc1 L_m_nozero
  s_lshl_b32 s23, s2, 8
  s_mov_b64 exec, 1
  buffer_store_dword v61, v61, s[40:43], s23 offen sc1
  s_mov_b64 exec, -1
L_m_nozero:
  s_and_b32 s24, s2, 63
  s_mul_i32 s24, s24, 256
  s_lshr_b32 s23, s2, 6
  s_lshl_b32 s23, s23, 2
  s_add_u32 s24, s24, s23
  s_add_u32 s24, s24, 65536
  s_waitcnt vmcnt(0)
  v_mov_b32 v58, 158724
  v_mov_b32 v59, 1
  v_mov_b32 v61, 0
  s_mov_b64 exec, 1
  ds_add_rtn_u32 v60, v58, v59
  s_waitcnt lgkmcnt(0)
  v_readfirstlane_b32 s23, v60
  s_nop 0
  s_cmp_lg_u32 s23, 3
  s_cbranch_scc1 L_lnd_notlast
  v_mov_b32 v59, s101
  buffer_store_dword v59, v61, s[40:43], s24 offen sc1
L_lnd_notlast:
  s_mov_b64 exec, -1
  s_lshr_b32 s29, s2, 3
  s_lshl_b32 s29, s29, 2
  s_add_u32 s29, s29, s20
  s_mov_b32 s32, s96
  s_mov_b32 s33, s97
  s_mov_b32 s34, 0x1200000
  s_mov_b32 s35, 0x20000
  s_cmp_lg_u32 s20, 1
  s_cbranch_scc1 L_ln_nox8
  s_lshl_b32 s23, s2, 8
  s_add_u32 s23, s23, 2097152
  buffer_store_dwordx4 v[40:43], v9, s[16:19], s23 offen sc1
L_ln_nox8:
  buffer_store_dwordx4 v[24:27], v9, s[16:19], s22 offen sc1
  s_add_u32 s22, s22, 1048576
  buffer_store_dwordx4 v[32:35], v9, s[16:19], s22 offen sc1
  s_and_b32 s24, s2, 63
  s_mul_i32 s24, s24, 256
  s_lshr_b32 s23, s2, 6
  s_lshl_b32 s23, s23, 2
  s_add_u32 s24, s24, s23
  s_add_u32 s24, s24, 196608
  s_cmp_ge_u32 s2, 216
  s_cbranch_scc1 L_m_conv
  v_lshrrev_b32 v30, 4, v1
  v_mul_u32_u24 v30, 9216, v30
  v_and_b32 v31, 15, v1
  v_lshl_add_u32 v30, v31, 4, v30
  s_and_b32 s44, s2, 7
  s_mul_i32 s44, s44, 9
  s_lshr_b32 s44, s44, 1
  s_lshl_b32 s44, s44, 8
  s_add_u32 s46, s29, 480
  s_mul_i32 s47, s46, 13108
  s_lshr_b32 s47, s47, 16
  s_mul_i32 s45, s47, 5
  s_sub_u32 s46, s46, s45
  s_mul_i32 s47, s47, 36864
  s_lshl_b32 s46, s46, 8
  s_add_u32 s47, s47, s46
  s_add_u32 s47, s47, s44
  buffer_load_dwordx4 v[168:171], v30, s[32:35], s47 offen
  s_add_u32 s46, s29, 588
  s_mul_i32 s47, s46, 13108
  s_lshr_b32 s47, s47, 16
  s_mul_i32 s45, s47, 5
  s_sub_u32 s46, s46, s45
  s_mul_i32 s47, s47, 36864
  s_lshl_b32 s46, s46, 8
  s_add_u32 s47, s47, s46
  s_add_u32 s47, s47, s44
  buffer_load_dwordx4 v[168:171], v30, s[32:35], s47 offen
  s_add_u32 s46, s29, 696
  s_mul_i32 s47, s46, 13108
  s_lshr_b32 s47, s47, 16
  s_mul_i32 s45, s47, 5
  s_sub_u32 s46, s46, s45
  s_mul_i32 s47, s47, 36864
  s_lshl_b32 s46, s46, 8
  s_add_u32 s47, s47, s46
  s_add_u32 s47, s47, s44
  buffer_load_dwordx4 v[168:171], v30, s[32:35], s47 offen
  s_waitcnt vmcnt(3)
  v_mov_b32 v58, 158732
  v_mov_b32 v59, 1
  v_mov_b32 v61, 0
  s_mov_b64 exec, 1
  ds_add_rtn_u32 v60, v58, v59
  s_waitcnt lgkmcnt(0)
  v_readfirstlane_b32 s23, v60
  s_nop 0
  s_cmp_lg_u32 s23, 3
  s_cbranch_scc1 L_xnd_notlast
  v_mov_b32 v59, s101
  buffer_store_dword v59, v61, s[40:43], s24 offen sc1
L_xnd_notlast:
  s_mov_b64 exec, -1
  s_mov_b32 s32, s98
  s_mov_b32 s33, s99
  s_mov_b32 s34, 0x1200000
  s_mov_b32 s35, 0x20000
  s_and_b32 s12, s2, 7
  s_lshr_b32 s13, s2, 3
  s_and_b32 s14, s12, 1
  s_mul_i32 s14, s14, 3
  s_add_u32 s13, s13, s14
  s_cmp_ge_u32 s13, 27
  s_cselect_b32 s14, 27, 0
  s_sub_u32 s13, s13, s14
  s_mul_i32 s12, s12, 27
  s_add_u32 s12, s12, s13
  s_mul_i32 s14, s12, 10923
  s_lshr_b32 s14, s14, 16
  s_mul_i32 s15, s14, 6
  s_sub_u32 s15, s12, s15
  v_and_b32 v1, 63, v0
  v_and_b32 v2, 15, v1
  v_lshrrev_b32 v3, 4, v1
  v_lshlrev_b32 v7, 4, v1
  v_bfe_u32 v4, v1, 2, 2
  v_lshl_add_u32 v5, v3, 3, v4
  v_and_b32 v6, 1, v3
  v_lshl_add_u32 v6, v6, 2, v4
  v_lshlrev_b32 v5, 8, v5
  v_and_b32 v8, 3, v1
  v_lshl_add_u32 v5, v8, 3, v5
  s_lshr_b32 s26, s20, 1
  s_lshl_b32 s26, s26, 2
  s_add_u32 s27, s26, 0
  v_xor_b32 v8, s27, v6
  v_lshl_add_u32 v48, v8, 5, v5
  v_add_u32 v52, 57344, v48
  s_add_u32 s27, s26, 1
  v_xor_b32 v8, s27, v6
  v_lshl_add_u32 v49, v8, 5, v5
  v_add_u32 v53, 57344, v49
  s_add_u32 s27, s26, 2
  v_xor_b32 v8, s27, v6
  v_lshl_add_u32 v50, v8, 5, v5
  v_add_u32 v54, 57344, v50
  s_add_u32 s27, s26, 3
  v_xor_b32 v8, s27, v6
  v_lshl_add_u32 v51, v8, 5, v5
  v_add_u32 v55, 57344, v51
  s_and_b32 s26, s20, 1
  s_mul_i32 s26, s26, 6144
  s_add_u32 s26, s26, 16384
  v_add_u32 v56, s26, v7
  v_add_u32 v57, 57344, v56
  s_mov_b32 s8, s38
  s_mov_b32 s9, s39
  s_mov_b32 s10, 0x2400
  s_mov_b32 s11, 0x20000
  s_lshr_b32 s16, s20, 1
  s_lshl_b32 s17, s16, 7
  s_lshl_b32 s18, s14, 8
  s_add_u32 s17, s17, s18
  v_lshlrev_b32 v9, 3, v3
  s_mov_b32 s22, s17
  buffer_load_dwordx2 v[12:13], v9, s[8:11], s22 offen offset:0
  buffer_load_dwordx2 v[14:15], v9, s[8:11], s22 offen offset:32
  buffer_load_dwordx2 v[16:17], v9, s[8:11], s22 offen offset:64
  buffer_load_dwordx2 v[18:19], v9, s[8:11], s22 offen offset:96
  v_mov_b32 v64, 0
  v_mov_b32 v65, 0
  v_mov_b32 v66, 0
  v_mov_b32 v67, 0
  v_mov_b32 v68, 0
  v_mov_b32 v69, 0
  v_mov_b32 v70, 0
  v_mov_b32 v71, 0
  v_mov_b32 v72, 0
  v_mov_b32 v73, 0
  v_mov_b32 v74, 0
  v_mov_b32 v75, 0
  v_mov_b32 v76, 0
  v_mov_b32 v77, 0
  v_mov_b32 v78, 0
  v_mov_b32 v79, 0
  v_mov_b32 v80, 0
  v_mov_b32 v81, 0
  v_mov_b32 v82, 0
  v_mov_b32 v83, 0
  v_mov_b32 v84, 0
  v_mov_b32 v85, 0
  v_mov_b32 v86, 0
  v_mov_b32 v87, 0
  v_mov_b32 v88, 0
  v_mov_b32 v89, 0
  v_mov_b32 v90, 0
  v_mov_b32 v91, 0
  v_mov_b32 v92, 0
  v_mov_b32 v93, 0
  v_mov_b32 v94, 0
  v_mov_b32 v95, 0
  v_mov_b32 v96, 0
  v_mov_b32 v97, 0
  v_mov_b32 v98, 0
  v_mov_b32 v99, 0
  v_mov_b32 v100, 0
  v_mov_b32 v101, 0
  v_mov_b32 v102, 0
  v_mov_b32 v103, 0
  v_mov_b32 v104, 0
  v_mov_b32 v105, 0
  v_mov_b32 v106, 0
  v_mov_b32 v107, 0
  v_mov_b32 v108, 0
  v_mov_b32 v109, 0
  v_mov_b32 v110, 0
  v_mov_b32 v111, 0
  s_add_u32 s44, s4, 0x4c0000
  s_addc_u32 s45, s5, 0
  s_mov_b32 s46, 0x510000
  s_mov_b32 s47, 0x20000
  s_and_b32 s17, s20, 1
  s_mul_i32 s17, s17, 3
  s_mul_i32 s18, s15, 6
  s_add_u32 s17, s17, s18
  s_lshl_b32 s17, s17, 11
  s_lshl_b32 s18, s14, 1
  s_add_u32 s18, s18, s16
  s_mul_i32 s18, s18, 73728
  s_add_u32 s17, s17, s18
  s_mul_i32 s24, s15, 36
  s_add_u32 s24, s24, s14
  s_lshl_b32 s24, s24, 8
  s_add_u32 s24, s24, 131072
  s_load_dwordx4 s[52:55], s[0:1], 88
  s_waitcnt lgkmcnt(0)
  s_barrier
  ds_read_b128 v[128:131], v56 offset:0
  ds_read_b64_tr_b16 v[112:113], v48 offset:0
  ds_read_b64_tr_b16 v[114:115], v48 offset:1024
  ds_read_b128 v[132:135], v56 offset:2048
  ds_read_b128 v[136:139], v56 offset:4096
  ds_read_b64_tr_b16 v[116:117], v49 offset:0
  ds_read_b64_tr_b16 v[118:119], v49 offset:1024
  ds_read_b64_tr_b16 v[120:121], v50 offset:0
  ds_read_b64_tr_b16 v[122:123], v50 offset:1024
  ds_read_b64_tr_b16 v[124:125], v51 offset:0
  ds_read_b64_tr_b16 v[126:127], v51 offset:1024
  s_mov_b32 s25, 7
.p2align 6
L_g1_loop:
  s_waitcnt lgkmcnt(6)
  v_mfma_f32_16x16x32_bf16 v[64:67], v[112:115], v[128:131], v[64:67]
  ds_read_b128 v[156:159], v56 offset:1024
  ds_read_b64_tr_b16 v[140:141], v48 offset:8192
  v_mfma_f32_16x16x32_bf16 v[68:71], v[112:115], v[132:135], v[68:71]
  ds_read_b64_tr_b16 v[142:143], v48 offset:9216
  ds_read_b128 v[160:163], v56 offset:3072
  v_mfma_f32_16x16x32_bf16 v[72:75], v[112:115], v[136:139], v[72:75]
  s_waitcnt lgkmcnt(8)
  ds_read_b128 v[164:167], v56 offset:5120
  v_mfma_f32_16x16x32_bf16 v[84:87], v[116:119], v[136:139], v[84:87]
  ds_read_b64_tr_b16 v[144:145], v49 offset:8192
  ds_read_b64_tr_b16 v[146:147], v49 offset:9216
  v_mfma_f32_16x16x32_bf16 v[80:83], v[116:119], v[132:135], v[80:83]
  ds_read_b64_tr_b16 v[148:149], v50 offset:8192
  ds_read_b64_tr_b16 v[150:151], v50 offset:9216
  v_mfma_f32_16x16x32_bf16 v[76:79], v[116:119], v[128:131], v[76:79]
  s_waitcnt lgkmcnt(9)
  ds_read_b64_tr_b16 v[152:153], v51 offset:8192
  v_mfma_f32_16x16x32_bf16 v[88:91], v[120:123], v[128:131], v[88:91]
  ds_read_b64_tr_b16 v[154:155], v51 offset:9216
  v_mfma_f32_16x16x32_bf16 v[92:95], v[120:123], v[132:135], v[92:95]
  v_mfma_f32_16x16x32_bf16 v[96:99], v[120:123], v[136:139], v[96:99]
  v_mfma_f32_16x16x32_bf16 v[108:111], v[124:127], v[136:139], v[108:111]
  v_mfma_f32_16x16x32_bf16 v[104:107], v[124:127], v[132:135], v[104:107]
  v_mfma_f32_16x16x32_bf16 v[100:103], v[124:127], v[128:131], v[100:103]
  s_waitcnt lgkmcnt(0)
  s_barrier
  v_mfma_f32_16x16x32_bf16 v[64:67], v[140:143], v[156:159], v[64:67]
  ds_read_b128 v[128:131], v56 offset:28672
  ds_read_b64_tr_b16 v[112:113], v48 offset:28672
  v_mfma_f32_16x16x32_bf16 v[68:71], v[140:143], v[160:163], v[68:71]
  ds_read_b64_tr_b16 v[114:115], v48 offset:29696
  ds_read_b128 v[132:135], v56 offset:30720
  v_mfma_f32_16x16x32_bf16 v[72:75], v[140:143], v[164:167], v[72:75]
  ds_read_b128 v[136:139], v56 offset:32768
  ds_read_b64_tr_b16 v[116:117], v49 offset:28672
  v_mfma_f32_16x16x32_bf16 v[84:87], v[144:147], v[164:167], v[84:87]
  ds_read_b64_tr_b16 v[118:119], v49 offset:29696
  ds_read_b64_tr_b16 v[120:121], v50 offset:28672
  v_mfma_f32_16x16x32_bf16 v[80:83], v[144:147], v[160:163], v[80:83]
  ds_read_b64_tr_b16 v[122:123], v50 offset:29696
  ds_read_b64_tr_b16 v[124:125], v51 offset:28672
  v_mfma_f32_16x16x32_bf16 v[76:79], v[144:147], v[156:159], v[76:79]
  ds_read_b64_tr_b16 v[126:127], v51 offset:29696
  v_mfma_f32_16x16x32_bf16 v[88:91], v[148:151], v[156:159], v[88:91]
  v_mfma_f32_16x16x32_bf16 v[92:95], v[148:151], v[160:163], v[92:95]
  v_mfma_f32_16x16x32_bf16 v[96:99], v[148:151], v[164:167], v[96:99]
  v_mfma_f32_16x16x32_bf16 v[108:111], v[152:155], v[164:167], v[108:111]
  v_mfma_f32_16x16x32_bf16 v[104:107], v[152:155], v[160:163], v[104:107]
  v_mfma_f32_16x16x32_bf16 v[100:103], v[152:155], v[156:159], v[100:103]
  s_waitcnt lgkmcnt(6)
  v_mfma_f32_16x16x32_bf16 v[64:67], v[112:115], v[128:131], v[64:67]
  ds_read_b128 v[156:159], v56 offset:29696
  ds_read_b64_tr_b16 v[140:141], v48 offset:36864
  v_mfma_f32_16x16x32_bf16 v[68:71], v[112:115], v[132:135], v[68:71]
  ds_read_b64_tr_b16 v[142:143], v48 offset:37888
  ds_read_b128 v[160:163], v56 offset:31744
  v_mfma_f32_16x16x32_bf16 v[72:75], v[112:115], v[136:139], v[72:75]
  s_waitcnt lgkmcnt(8)
  ds_read_b128 v[164:167], v56 offset:33792
  v_mfma_f32_16x16x32_bf16 v[84:87], v[116:119], v[136:139], v[84:87]
  ds_read_b64_tr_b16 v[144:145], v49 offset:36864
  ds_read_b64_tr_b16 v[146:147], v49 offset:37888
  v_mfma_f32_16x16x32_bf16 v[80:83], v[116:119], v[132:135], v[80:83]
  ds_read_b64_tr_b16 v[148:149], v50 offset:36864
  ds_read_b64_tr_b16 v[150:151], v50 offset:37888
  v_mfma_f32_16x16x32_bf16 v[76:79], v[116:119], v[128:131], v[76:79]
  s_waitcnt lgkmcnt(9)
  ds_read_b64_tr_b16 v[152:153], v51 offset:36864
  v_mfma_f32_16x16x32_bf16 v[88:91], v[120:123], v[128:131], v[88:91]
  ds_read_b64_tr_b16 v[154:155], v51 offset:37888
  v_mfma_f32_16x16x32_bf16 v[92:95], v[120:123], v[132:135], v[92:95]
  v_mfma_f32_16x16x32_bf16 v[96:99], v[120:123], v[136:139], v[96:99]
  v_mfma_f32_16x16x32_bf16 v[108:111], v[124:127], v[136:139], v[108:111]
  v_mfma_f32_16x16x32_bf16 v[104:107], v[124:127], v[132:135], v[104:107]
  v_mfma_f32_16x16x32_bf16 v[100:103], v[124:127], v[128:131], v[100:103]
  s_waitcnt lgkmcnt(0)
  s_barrier
  v_mfma_f32_16x16x32_bf16 v[64:67], v[140:143], v[156:159], v[64:67]
  ds_read_b128 v[128:131], v57 offset:0
  ds_read_b64_tr_b16 v[112:113], v52 offset:0
  v_mfma_f32_16x16x32_bf16 v[68:71], v[140:143], v[160:163], v[68:71]
  ds_read_b64_tr_b16 v[114:115], v52 offset:1024
  ds_read_b128 v[132:135], v57 offset:2048
  v_mfma_f32_16x16x32_bf16 v[72:75], v[140:143], v[164:167], v[72:75]
  ds_read_b128 v[136:139], v57 offset:4096
  ds_read_b64_tr_b16 v[116:117], v53 offset:0
  v_mfma_f32_16x16x32_bf16 v[84:87], v[144:147], v[164:167], v[84:87]
  ds_read_b64_tr_b16 v[118:119], v53 offset:1024
  ds_read_b64_tr_b16 v[120:121], v54 offset:0
  v_mfma_f32_16x16x32_bf16 v[80:83], v[144:147], v[160:163], v[80:83]
  ds_read_b64_tr_b16 v[122:123], v54 offset:1024
  ds_read_b64_tr_b16 v[124:125], v55 offset:0
  v_mfma_f32_16x16x32_bf16 v[76:79], v[144:147], v[156:159], v[76:79]
  ds_read_b64_tr_b16 v[126:127], v55 offset:1024
  v_mfma_f32_16x16x32_bf16 v[88:91], v[148:151], v[156:159], v[88:91]
  v_mfma_f32_16x16x32_bf16 v[92:95], v[148:151], v[160:163], v[92:95]
  v_mfma_f32_16x16x32_bf16 v[96:99], v[148:151], v[164:167], v[96:99]
  v_mfma_f32_16x16x32_bf16 v[108:111], v[152:155], v[164:167], v[108:111]
  v_mfma_f32_16x16x32_bf16 v[104:107], v[152:155], v[160:163], v[104:107]
  v_mfma_f32_16x16x32_bf16 v[100:103], v[152:155], v[156:159], v[100:103]
  s_waitcnt lgkmcnt(6)
  v_mfma_f32_16x16x32_bf16 v[64:67], v[112:115], v[128:131], v[64:67]
  ds_read_b128 v[156:159], v57 offset:1024
  ds_read_b64_tr_b16 v[140:141], v52 offset:8192
  v_mfma_f32_16x16x32_bf16 v[68:71], v[112:115], v[132:135], v[68:71]
  ds_read_b64_tr_b16 v[142:143], v52 offset:9216
  ds_read_b128 v[160:163], v57 offset:3072
  v_mfma_f32_16x16x32_bf16 v[72:75], v[112:115], v[136:139], v[72:75]
  s_waitcnt lgkmcnt(8)
  ds_read_b128 v[164:167], v57 offset:5120
  v_mfma_f32_16x16x32_bf16 v[84:87], v[116:119], v[136:139], v[84:87]
  ds_read_b64_tr_b16 v[144:145], v53 offset:8192
  ds_read_b64_tr_b16 v[146:147], v53 offset:9216
  v_mfma_f32_16x16x32_bf16 v[80:83], v[116:119], v[132:135], v[80:83]
  ds_read_b64_tr_b16 v[148:149], v54 offset:8192
  ds_read_b64_tr_b16 v[150:151], v54 offset:9216
  v_mfma_f32_16x16x32_bf16 v[76:79], v[116:119], v[128:131], v[76:79]
  s_waitcnt lgkmcnt(9)
  ds_read_b64_tr_b16 v[152:153], v55 offset:8192
  v_mfma_f32_16x16x32_bf16 v[88:91], v[120:123], v[128:131], v[88:91]
  ds_read_b64_tr_b16 v[154:155], v55 offset:9216
  v_mfma_f32_16x16x32_bf16 v[92:95], v[120:123], v[132:135], v[92:95]
  v_mfma_f32_16x16x32_bf16 v[96:99], v[120:123], v[136:139], v[96:99]
  v_mfma_f32_16x16x32_bf16 v[108:111], v[124:127], v[136:139], v[108:111]
  v_mfma_f32_16x16x32_bf16 v[104:107], v[124:127], v[132:135], v[104:107]
  v_mfma_f32_16x16x32_bf16 v[100:103], v[124:127], v[128:131], v[100:103]
  s_waitcnt lgkmcnt(0)
  s_barrier
  v_mfma_f32_16x16x32_bf16 v[64:67], v[140:143], v[156:159], v[64:67]
  ds_read_b128 v[128:131], v57 offset:28672
  ds_read_b64_tr_b16 v[112:113], v52 offset:28672
  v_mfma_f32_16x16x32_bf16 v[68:71], v[140:143], v[160:163], v[68:71]
  ds_read_b64_tr_b16 v[114:115], v52 offset:29696
  ds_read_b128 v[132:135], v57 offset:30720
  v_mfma_f32_16x16x32_bf16 v[72:75], v[140:143], v[164:167], v[72:75]
  ds_read_b128 v[136:139], v57 offset:32768
  ds_read_b64_tr_b16 v[116:117], v53 offset:28672
  v_mfma_f32_16x16x32_bf16 v[84:87], v[144:147], v[164:167], v[84:87]
  ds_read_b64_tr_b16 v[118:119], v53 offset:29696
  ds_read_b64_tr_b16 v[120:121], v54 offset:28672
  v_mfma_f32_16x16x32_bf16 v[80:83], v[144:147], v[160:163], v[80:83]
  ds_read_b64_tr_b16 v[122:123], v54 offset:29696
  ds_read_b64_tr_b16 v[124:125], v55 offset:28672
  v_mfma_f32_16x16x32_bf16 v[76:79], v[144:147], v[156:159], v[76:79]
  ds_read_b64_tr_b16 v[126:127], v55 offset:29696
  v_mfma_f32_16x16x32_bf16 v[88:91], v[148:151], v[156:159], v[88:91]
  v_mfma_f32_16x16x32_bf16 v[92:95], v[148:151], v[160:163], v[92:95]
  v_mfma_f32_16x16x32_bf16 v[96:99], v[148:151], v[164:167], v[96:99]
  v_mfma_f32_16x16x32_bf16 v[108:111], v[152:155], v[164:167], v[108:111]
  v_mfma_f32_16x16x32_bf16 v[104:107], v[152:155], v[160:163], v[104:107]
  v_mfma_f32_16x16x32_bf16 v[100:103], v[152:155], v[156:159], v[100:103]
  s_waitcnt lgkmcnt(6)
  v_mfma_f32_16x16x32_bf16 v[64:67], v[112:115], v[128:131], v[64:67]
  ds_read_b128 v[156:159], v57 offset:29696
  ds_read_b64_tr_b16 v[140:141], v52 offset:36864
  v_mfma_f32_16x16x32_bf16 v[68:71], v[112:115], v[132:135], v[68:71]
  ds_read_b64_tr_b16 v[142:143], v52 offset:37888
  ds_read_b128 v[160:163], v57 offset:31744
  v_mfma_f32_16x16x32_bf16 v[72:75], v[112:115], v[136:139], v[72:75]
  s_waitcnt lgkmcnt(8)
  ds_read_b128 v[164:167], v57 offset:33792
  v_mfma_f32_16x16x32_bf16 v[84:87], v[116:119], v[136:139], v[84:87]
  ds_read_b64_tr_b16 v[144:145], v53 offset:36864
  ds_read_b64_tr_b16 v[146:147], v53 offset:37888
  v_mfma_f32_16x16x32_bf16 v[80:83], v[116:119], v[132:135], v[80:83]
  ds_read_b64_tr_b16 v[148:149], v54 offset:36864
  ds_read_b64_tr_b16 v[150:151], v54 offset:37888
  v_mfma_f32_16x16x32_bf16 v[76:79], v[116:119], v[128:131], v[76:79]
  s_waitcnt lgkmcnt(9)
  ds_read_b64_tr_b16 v[152:153], v55 offset:36864
  v_mfma_f32_16x16x32_bf16 v[88:91], v[120:123], v[128:131], v[88:91]
  ds_read_b64_tr_b16 v[154:155], v55 offset:37888
  v_mfma_f32_16x16x32_bf16 v[92:95], v[120:123], v[132:135], v[92:95]
  v_mfma_f32_16x16x32_bf16 v[96:99], v[120:123], v[136:139], v[96:99]
  v_mfma_f32_16x16x32_bf16 v[108:111], v[124:127], v[136:139], v[108:111]
  v_mfma_f32_16x16x32_bf16 v[104:107], v[124:127], v[132:135], v[104:107]
  v_mfma_f32_16x16x32_bf16 v[100:103], v[124:127], v[128:131], v[100:103]
  s_waitcnt lgkmcnt(0)
  s_barrier
  v_mfma_f32_16x16x32_bf16 v[64:67], v[140:143], v[156:159], v[64:67]
  ds_read_b128 v[128:131], v56 offset:0
  ds_read_b64_tr_b16 v[112:113], v48 offset:0
  v_mfma_f32_16x16x32_bf16 v[68:71], v[140:143], v[160:163], v[68:71]
  ds_read_b64_tr_b16 v[114:115], v48 offset:1024
  ds_read_b128 v[132:135], v56 offset:2048
  v_mfma_f32_16x16x32_bf16 v[72:75], v[140:143], v[164:167], v[72:75]
  ds_read_b128 v[136:139], v56 offset:4096
  ds_read_b64_tr_b16 v[116:117], v49 offset:0
  v_mfma_f32_16x16x32_bf16 v[84:87], v[144:147], v[164:167], v[84:87]
  ds_read_b64_tr_b16 v[118:119], v49 offset:1024
  ds_read_b64_tr_b16 v[120:121], v50 offset:0
  v_mfma_f32_16x16x32_bf16 v[80:83], v[144:147], v[160:163], v[80:83]
  ds_read_b64_tr_b16 v[122:123], v50 offset:1024
  ds_read_b64_tr_b16 v[124:125], v51 offset:0
  v_mfma_f32_16x16x32_bf16 v[76:79], v[144:147], v[156:159], v[76:79]
  ds_read_b64_tr_b16 v[126:127], v51 offset:1024
  v_mfma_f32_16x16x32_bf16 v[88:91], v[148:151], v[156:159], v[88:91]
  v_mfma_f32_16x16x32_bf16 v[92:95], v[148:151], v[160:163], v[92:95]
  v_mfma_f32_16x16x32_bf16 v[96:99], v[148:151], v[164:167], v[96:99]
  v_mfma_f32_16x16x32_bf16 v[108:111], v[152:155], v[164:167], v[108:111]
  v_mfma_f32_16x16x32_bf16 v[104:107], v[152:155], v[160:163], v[104:107]
  v_mfma_f32_16x16x32_bf16 v[100:103], v[152:155], v[156:159], v[100:103]
  s_sub_u32 s25, s25, 1
  s_cmp_lg_u32 s25, 0
  s_cbranch_scc1 L_g1_loop
  s_waitcnt lgkmcnt(6)
  v_mfma_f32_16x16x32_bf16 v[64:67], v[112:115], v[128:131], v[64:67]
  ds_read_b128 v[156:159], v56 offset:1024
  ds_read_b64_tr_b16 v[140:141], v48 offset:8192
  v_mfma_f32_16x16x32_bf16 v[68:71], v[112:115], v[132:135], v[68:71]
  ds_read_b64_tr_b16 v[142:143], v48 offset:9216
  ds_read_b128 v[160:163], v56 offset:3072
  v_mfma_f32_16x16x32_bf16 v[72:75], v[112:115], v[136:139], v[72:75]
  s_waitcnt lgkmcnt(8)
  ds_read_b128 v[164:167], v56 offset:5120
  v_mfma_f32_16x16x32_bf16 v[84:87], v[116:119], v[136:139], v[84:87]
  ds_read_b64_tr_b16 v[144:145], v49 offset:8192
  ds_read_b64_tr_b16 v[146:147], v49 offset:9216
  v_mfma_f32_16x16x32_bf16 v[80:83], v[116:119], v[132:135], v[80:83]
  ds_read_b64_tr_b16 v[148:149], v50 offset:8192
  ds_read_b64_tr_b16 v[150:151], v50 offset:9216
  v_mfma_f32_16x16x32_bf16 v[76:79], v[116:119], v[128:131], v[76:79]
  s_waitcnt lgkmcnt(9)
  ds_read_b64_tr_b16 v[152:153], v51 offset:8192
  v_mfma_f32_16x16x32_bf16 v[88:91], v[120:123], v[128:131], v[88:91]
  ds_read_b64_tr_b16 v[154:155], v51 offset:9216
  v_mfma_f32_16x16x32_bf16 v[92:95], v[120:123], v[132:135], v[92:95]
  v_mfma_f32_16x16x32_bf16 v[96:99], v[120:123], v[136:139], v[96:99]
  v_mfma_f32_16x16x32_bf16 v[108:111], v[124:127], v[136:139], v[108:111]
  v_mfma_f32_16x16x32_bf16 v[104:107], v[124:127], v[132:135], v[104:107]
  v_mfma_f32_16x16x32_bf16 v[100:103], v[124:127], v[128:131], v[100:103]
  s_waitcnt lgkmcnt(0)
  s_barrier
  v_mfma_f32_16x16x32_bf16 v[64:67], v[140:143], v[156:159], v[64:67]
  ds_read_b128 v[128:131], v56 offset:28672
  ds_read_b64_tr_b16 v[112:113], v48 offset:28672
  v_mfma_f32_16x16x32_bf16 v[68:71], v[140:143], v[160:163], v[68:71]
  ds_read_b64_tr_b16 v[114:115], v48 offset:29696
  ds_read_b128 v[132:135], v56 offset:30720
  v_mfma_f32_16x16x32_bf16 v[72:75], v[140:143], v[164:167], v[72:75]
  ds_read_b128 v[136:139], v56 offset:32768
  ds_read_b64_tr_b16 v[116:117], v49 offset:28672
  v_mfma_f32_16x16x32_bf16 v[84:87], v[144:147], v[164:167], v[84:87]
  ds_read_b64_tr_b16 v[118:119], v49 offset:29696
  ds_read_b64_tr_b16 v[120:121], v50 offset:28672
  v_mfma_f32_16x16x32_bf16 v[80:83], v[144:147], v[160:163], v[80:83]
  ds_read_b64_tr_b16 v[122:123], v50 offset:29696
  ds_read_b64_tr_b16 v[124:125], v51 offset:28672
  v_mfma_f32_16x16x32_bf16 v[76:79], v[144:147], v[156:159], v[76:79]
  ds_read_b64_tr_b16 v[126:127], v51 offset:29696
  v_mfma_f32_16x16x32_bf16 v[88:91], v[148:151], v[156:159], v[88:91]
  v_mfma_f32_16x16x32_bf16 v[92:95], v[148:151], v[160:163], v[92:95]
  v_mfma_f32_16x16x32_bf16 v[96:99], v[148:151], v[164:167], v[96:99]
  v_mfma_f32_16x16x32_bf16 v[108:111], v[152:155], v[164:167], v[108:111]
  v_mfma_f32_16x16x32_bf16 v[104:107], v[152:155], v[160:163], v[104:107]
  v_mfma_f32_16x16x32_bf16 v[100:103], v[152:155], v[156:159], v[100:103]
  s_waitcnt lgkmcnt(6)
  v_mfma_f32_16x16x32_bf16 v[64:67], v[112:115], v[128:131], v[64:67]
  ds_read_b128 v[156:159], v56 offset:29696
  ds_read_b64_tr_b16 v[140:141], v48 offset:36864
  v_mfma_f32_16x16x32_bf16 v[68:71], v[112:115], v[132:135], v[68:71]
  ds_read_b64_tr_b16 v[142:143], v48 offset:37888
  ds_read_b128 v[160:163], v56 offset:31744
  v_mfma_f32_16x16x32_bf16 v[72:75], v[112:115], v[136:139], v[72:75]
  s_waitcnt lgkmcnt(8)
  ds_read_b128 v[164:167], v56 offset:33792
  v_mfma_f32_16x16x32_bf16 v[84:87], v[116:119], v[136:139], v[84:87]
  ds_read_b64_tr_b16 v[144:145], v49 offset:36864
  ds_read_b64_tr_b16 v[146:147], v49 offset:37888
  v_mfma_f32_16x16x32_bf16 v[80:83], v[116:119], v[132:135], v[80:83]
  ds_read_b64_tr_b16 v[148:149], v50 offset:36864
  ds_read_b64_tr_b16 v[150:151], v50 offset:37888
  v_mfma_f32_16x16x32_bf16 v[76:79], v[116:119], v[128:131], v[76:79]
  s_waitcnt lgkmcnt(9)
  ds_read_b64_tr_b16 v[152:153], v51 offset:36864
  v_mfma_f32_16x16x32_bf16 v[88:91], v[120:123], v[128:131], v[88:91]
  ds_read_b64_tr_b16 v[154:155], v51 offset:37888
  v_mfma_f32_16x16x32_bf16 v[92:95], v[120:123], v[132:135], v[92:95]
  v_mfma_f32_16x16x32_bf16 v[96:99], v[120:123], v[136:139], v[96:99]
  v_mfma_f32_16x16x32_bf16 v[108:111], v[124:127], v[136:139], v[108:111]
  v_mfma_f32_16x16x32_bf16 v[104:107], v[124:127], v[132:135], v[104:107]
  v_mfma_f32_16x16x32_bf16 v[100:103], v[124:127], v[128:131], v[100:103]
  s_waitcnt lgkmcnt(0)
  s_barrier
  v_mfma_f32_16x16x32_bf16 v[64:67], v[140:143], v[156:159], v[64:67]
  ds_read_b128 v[128:131], v57 offset:0
  ds_read_b64_tr_b16 v[112:113], v52 offset:0
  v_mfma_f32_16x16x32_bf16 v[68:71], v[140:143], v[160:163], v[68:71]
  ds_read_b64_tr_b16 v[114:115], v52 offset:1024
  ds_read_b128 v[132:135], v57 offset:2048
  v_mfma_f32_16x16x32_bf16 v[72:75], v[140:143], v[164:167], v[72:75]
  ds_read_b128 v[136:139], v57 offset:4096
  ds_read_b64_tr_b16 v[116:117], v53 offset:0
  v_mfma_f32_16x16x32_bf16 v[84:87], v[144:147], v[164:167], v[84:87]
  ds_read_b64_tr_b16 v[118:119], v53 offset:1024
  ds_read_b64_tr_b16 v[120:121], v54 offset:0
  v_mfma_f32_16x16x32_bf16 v[80:83], v[144:147], v[160:163], v[80:83]
  ds_read_b64_tr_b16 v[122:123], v54 offset:1024
  ds_read_b64_tr_b16 v[124:125], v55 offset:0
  v_mfma_f32_16x16x32_bf16 v[76:79], v[144:147], v[156:159], v[76:79]
  ds_read_b64_tr_b16 v[126:127], v55 offset:1024
  v_mfma_f32_16x16x32_bf16 v[88:91], v[148:151], v[156:159], v[88:91]
  v_mfma_f32_16x16x32_bf16 v[92:95], v[148:151], v[160:163], v[92:95]
  v_mfma_f32_16x16x32_bf16 v[96:99], v[148:151], v[164:167], v[96:99]
  v_mfma_f32_16x16x32_bf16 v[108:111], v[152:155], v[164:167], v[108:111]
  v_mfma_f32_16x16x32_bf16 v[104:107], v[152:155], v[160:163], v[104:107]
  v_mfma_f32_16x16x32_bf16 v[100:103], v[152:155], v[156:159], v[100:103]
  s_waitcnt lgkmcnt(6)
  v_mfma_f32_16x16x32_bf16 v[64:67], v[112:115], v[128:131], v[64:67]
  ds_read_b128 v[156:159], v57 offset:1024
  ds_read_b64_tr_b16 v[140:141], v52 offset:8192
  v_mfma_f32_16x16x32_bf16 v[68:71], v[112:115], v[132:135], v[68:71]
  ds_read_b64_tr_b16 v[142:143], v52 offset:9216
  ds_read_b128 v[160:163], v57 offset:3072
  v_mfma_f32_16x16x32_bf16 v[72:75], v[112:115], v[136:139], v[72:75]
  s_waitcnt lgkmcnt(8)
  ds_read_b128 v[164:167], v57 offset:5120
  v_mfma_f32_16x16x32_bf16 v[84:87], v[116:119], v[136:139], v[84:87]
  ds_read_b64_tr_b16 v[144:145], v53 offset:8192
  ds_read_b64_tr_b16 v[146:147], v53 offset:9216
  v_mfma_f32_16x16x32_bf16 v[80:83], v[116:119], v[132:135], v[80:83]
  ds_read_b64_tr_b16 v[148:149], v54 offset:8192
  ds_read_b64_tr_b16 v[150:151], v54 offset:9216
  v_mfma_f32_16x16x32_bf16 v[76:79], v[116:119], v[128:131], v[76:79]
  s_waitcnt lgkmcnt(9)
  ds_read_b64_tr_b16 v[152:153], v55 offset:8192
  v_mfma_f32_16x16x32_bf16 v[88:91], v[120:123], v[128:131], v[88:91]
  ds_read_b64_tr_b16 v[154:155], v55 offset:9216
  v_mfma_f32_16x16x32_bf16 v[92:95], v[120:123], v[132:135], v[92:95]
  v_mfma_f32_16x16x32_bf16 v[96:99], v[120:123], v[136:139], v[96:99]
  v_mfma_f32_16x16x32_bf16 v[108:111], v[124:127], v[136:139], v[108:111]
  v_mfma_f32_16x16x32_bf16 v[104:107], v[124:127], v[132:135], v[104:107]
  v_mfma_f32_16x16x32_bf16 v[100:103], v[124:127], v[128:131], v[100:103]
  s_waitcnt lgkmcnt(0)
  s_barrier
  v_mfma_f32_16x16x32_bf16 v[64:67], v[140:143], v[156:159], v[64:67]
  ds_read_b128 v[128:131], v57 offset:28672
  ds_read_b64_tr_b16 v[112:113], v52 offset:28672
  v_mfma_f32_16x16x32_bf16 v[68:71], v[140:143], v[160:163], v[68:71]
  ds_read_b64_tr_b16 v[114:115], v52 offset:29696
  ds_read_b128 v[132:135], v57 offset:30720
  v_mfma_f32_16x16x32_bf16 v[72:75], v[140:143], v[164:167], v[72:75]
  ds_read_b128 v[136:139], v57 offset:32768
  ds_read_b64_tr_b16 v[116:117], v53 offset:28672
  v_mfma_f32_16x16x32_bf16 v[84:87], v[144:147], v[164:167], v[84:87]
  ds_read_b64_tr_b16 v[118:119], v53 offset:29696
  ds_read_b64_tr_b16 v[120:121], v54 offset:28672
  v_mfma_f32_16x16x32_bf16 v[80:83], v[144:147], v[160:163], v[80:83]
  ds_read_b64_tr_b16 v[122:123], v54 offset:29696
  ds_read_b64_tr_b16 v[124:125], v55 offset:28672
  v_mfma_f32_16x16x32_bf16 v[76:79], v[144:147], v[156:159], v[76:79]
  ds_read_b64_tr_b16 v[126:127], v55 offset:29696
  v_mfma_f32_16x16x32_bf16 v[88:91], v[148:151], v[156:159], v[88:91]
  v_mfma_f32_16x16x32_bf16 v[92:95], v[148:151], v[160:163], v[92:95]
  v_mfma_f32_16x16x32_bf16 v[96:99], v[148:151], v[164:167], v[96:99]
  v_mfma_f32_16x16x32_bf16 v[108:111], v[152:155], v[164:167], v[108:111]
  v_mfma_f32_16x16x32_bf16 v[104:107], v[152:155], v[160:163], v[104:107]
  v_mfma_f32_16x16x32_bf16 v[100:103], v[152:155], v[156:159], v[100:103]
  s_waitcnt lgkmcnt(6)
  v_mfma_f32_16x16x32_bf16 v[64:67], v[112:115], v[128:131], v[64:67]
  ds_read_b128 v[156:159], v57 offset:29696
  ds_read_b64_tr_b16 v[140:141], v52 offset:36864
  v_mfma_f32_16x16x32_bf16 v[68:71], v[112:115], v[132:135], v[68:71]
  ds_read_b64_tr_b16 v[142:143], v52 offset:37888
  ds_read_b128 v[160:163], v57 offset:31744
  v_mfma_f32_16x16x32_bf16 v[72:75], v[112:115], v[136:139], v[72:75]
  s_waitcnt lgkmcnt(8)
  ds_read_b128 v[164:167], v57 offset:33792
  v_mfma_f32_16x16x32_bf16 v[84:87], v[116:119], v[136:139], v[84:87]
  ds_read_b64_tr_b16 v[144:145], v53 offset:36864
  ds_read_b64_tr_b16 v[146:147], v53 offset:37888
  v_mfma_f32_16x16x32_bf16 v[80:83], v[116:119], v[132:135], v[80:83]
  ds_read_b64_tr_b16 v[148:149], v54 offset:36864
  ds_read_b64_tr_b16 v[150:151], v54 offset:37888
  v_mfma_f32_16x16x32_bf16 v[76:79], v[116:119], v[128:131], v[76:79]
  s_waitcnt lgkmcnt(9)
  ds_read_b64_tr_b16 v[152:153], v55 offset:36864
  v_mfma_f32_16x16x32_bf16 v[88:91], v[120:123], v[128:131], v[88:91]
  ds_read_b64_tr_b16 v[154:155], v55 offset:37888
  v_mfma_f32_16x16x32_bf16 v[92:95], v[120:123], v[132:135], v[92:95]
  v_mfma_f32_16x16x32_bf16 v[96:99], v[120:123], v[136:139], v[96:99]
  v_mfma_f32_16x16x32_bf16 v[108:111], v[124:127], v[136:139], v[108:111]
  v_mfma_f32_16x16x32_bf16 v[104:107], v[124:127], v[132:135], v[104:107]
  v_mfma_f32_16x16x32_bf16 v[100:103], v[124:127], v[128:131], v[100:103]
  s_waitcnt lgkmcnt(0)
  s_barrier
  v_mfma_f32_16x16x32_bf16 v[64:67], v[140:143], v[156:159], v[64:67]
  v_mfma_f32_16x16x32_bf16 v[68:71], v[140:143], v[160:163], v[68:71]
  v_mfma_f32_16x16x32_bf16 v[72:75], v[140:143], v[164:167], v[72:75]
  v_mfma_f32_16x16x32_bf16 v[84:87], v[144:147], v[164:167], v[84:87]
  v_mfma_f32_16x16x32_bf16 v[80:83], v[144:147], v[160:163], v[80:83]
  v_mfma_f32_16x16x32_bf16 v[76:79], v[144:147], v[156:159], v[76:79]
  v_mfma_f32_16x16x32_bf16 v[88:91], v[148:151], v[156:159], v[88:91]
  v_mfma_f32_16x16x32_bf16 v[92:95], v[148:151], v[160:163], v[92:95]
  v_mfma_f32_16x16x32_bf16 v[96:99], v[148:151], v[164:167], v[96:99]
  v_mfma_f32_16x16x32_bf16 v[108:111], v[152:155], v[164:167], v[108:111]
  v_mfma_f32_16x16x32_bf16 v[104:107], v[152:155], v[160:163], v[104:107]
  v_mfma_f32_16x16x32_bf16 v[100:103], v[152:155], v[156:159], v[100:103]
  s_waitcnt vmcnt(0)
  s_mov_b32 s48, 0xbdd2d3e8
  s_mov_b32 s49, s48
  v_mov_b32 v36, 0xc0135761
  v_mov_b32 v37, v36
  v_lshlrev_b32 v20, 16, v12
  v_and_b32 v21, 0xffff0000, v12
  v_lshlrev_b32 v22, 16, v13
  v_and_b32 v23, 0xffff0000, v13
  v_lshlrev_b32 v24, 16, v14
  v_and_b32 v25, 0xffff0000, v14
  v_lshlrev_b32 v26, 16, v15
  v_and_b32 v27, 0xffff0000, v15
  v_lshlrev_b32 v28, 16, v16
  v_and_b32 v29, 0xffff0000, v16
  v_lshlrev_b32 v30, 16, v17
  v_and_b32 v31, 0xffff0000, v17
  v_lshlrev_b32 v32, 16, v18
  v_and_b32 v33, 0xffff0000, v18
  v_lshlrev_b32 v34, 16, v19
  v_and_b32 v35, 0xffff0000, v19
  s_lshr_b32 s26, s20, 1
  s_mul_i32 s26, s26, 28672
  s_and_b32 s27, s20, 1
  s_mul_i32 s27, s27, 6144
  s_add_u32 s26, s26, s27
  s_add_u32 s26, s26, 16384
  s_cmp_ge_u32 s2, 192
  s_cselect_b32 s26, 139264, s26
  v_add_u32 v38, s26, v7
  v_pk_add_f32 v[112:113], v[64:65], v[20:21]
  v_pk_add_f32 v[114:115], v[66:67], v[22:23]
  v_pk_add_f32 v[116:117], v[76:77], v[24:25]
  v_pk_add_f32 v[118:119], v[78:79], v[26:27]
  v_pk_mul_f32 v[120:121], v[112:113], v[112:113]
  v_pk_mul_f32 v[122:123], v[114:115], v[114:115]
  v_pk_mul_f32 v[124:125], v[116:117], v[116:117]
  v_pk_mul_f32 v[126:127], v[118:119], v[118:119]
  v_pk_fma_f32 v[120:121], v[120:121], s[48:49], v[36:37]
  v_pk_fma_f32 v[122:123], v[122:123], s[48:49], v[36:37]
  v_pk_fma_f32 v[124:125], v[124:125], s[48:49], v[36:37]
  v_pk_fma_f32 v[126:127], v[126:127], s[48:49], v[36:37]
  v_pk_mul_f32 v[120:121], v[120:121], v[112:113]
  v_pk_mul_f32 v[122:123], v[122:123], v[114:115]
  v_pk_mul_f32 v[124:125], v[124:125], v[116:117]
  v_pk_mul_f32 v[126:127], v[126:127], v[118:119]
  v_exp_f32 v120, v120
  v_exp_f32 v121, v121
  v_exp_f32 v122, v122
  v_exp_f32 v123, v123
  v_exp_f32 v124, v124
  v_exp_f32 v125, v125
  v_exp_f32 v126, v126
  v_exp_f32 v127, v127
  v_pk_add_f32 v[120:121], v[120:121], 1.0 op_sel_hi:[1,0]
  v_pk_add_f32 v[122:123], v[122:123], 1.0 op_sel_hi:[1,0]
  v_pk_add_f32 v[124:125], v[124:125], 1.0 op_sel_hi:[1,0]
  v_pk_add_f32 v[126:127], v[126:127], 1.0 op_sel_hi:[1,0]
  v_rcp_f32 v120, v120
  v_rcp_f32 v121, v121
  v_rcp_f32 v122, v122
  v_rcp_f32 v123, v123
  v_rcp_f32 v124, v124
  v_rcp_f32 v125, v125
  v_rcp_f32 v126, v126
  v_rcp_f32 v127, v127
  v_pk_mul_f32 v[112:113], v[112:113], v[120:121]
  v_pk_mul_f32 v[114:115], v[114:115], v[122:123]
  v_pk_mul_f32 v[116:117], v[116:117], v[124:125]
  v_pk_mul_f32 v[118:119], v[118:119], v[126:127]
  v_cvt_pk_bf16_f32 v132, v112, v113
  v_cvt_pk_bf16_f32 v133, v114, v115
  v_cvt_pk_bf16_f32 v134, v116, v117
  v_cvt_pk_bf16_f32 v135, v118, v119
  buffer_store_dwordx4 v[132:135], v7, s[44:47], s17 offen offset:0 sc1
  ds_write_b128 v38, v[132:135] offset:0
  v_pk_add_f32 v[112:113], v[88:89], v[28:29]
  v_pk_add_f32 v[114:115], v[90:91], v[30:31]
  v_pk_add_f32 v[116:117], v[100:101], v[32:33]
  v_pk_add_f32 v[118:119], v[102:103], v[34:35]
  v_pk_mul_f32 v[120:121], v[112:113], v[112:113]
  v_pk_mul_f32 v[122:123], v[114:115], v[114:115]
  v_pk_mul_f32 v[124:125], v[116:117], v[116:117]
  v_pk_mul_f32 v[126:127], v[118:119], v[118:119]
  v_pk_fma_f32 v[120:121], v[120:121], s[48:49], v[36:37]
  v_pk_fma_f32 v[122:123], v[122:123], s[48:49], v[36:37]
  v_pk_fma_f32 v[124:125], v[124:125], s[48:49], v[36:37]
  v_pk_fma_f32 v[126:127], v[126:127], s[48:49], v[36:37]
  v_pk_mul_f32 v[120:121], v[120:121], v[112:113]
  v_pk_mul_f32 v[122:123], v[122:123], v[114:115]
  v_pk_mul_f32 v[124:125], v[124:125], v[116:117]
  v_pk_mul_f32 v[126:127], v[126:127], v[118:119]
  v_exp_f32 v120, v120
  v_exp_f32 v121, v121
  v_exp_f32 v122, v122
  v_exp_f32 v123, v123
  v_exp_f32 v124, v124
  v_exp_f32 v125, v125
  v_exp_f32 v126, v126
  v_exp_f32 v127, v127
  v_pk_add_f32 v[120:121], v[120:121], 1.0 op_sel_hi:[1,0]
  v_pk_add_f32 v[122:123], v[122:123], 1.0 op_sel_hi:[1,0]
  v_pk_add_f32 v[124:125], v[124:125], 1.0 op_sel_hi:[1,0]
  v_pk_add_f32 v[126:127], v[126:127], 1.0 op_sel_hi:[1,0]
  v_rcp_f32 v120, v120
  v_rcp_f32 v121, v121
  v_rcp_f32 v122, v122
  v_rcp_f32 v123, v123
  v_rcp_f32 v124, v124
  v_rcp_f32 v125, v125
  v_rcp_f32 v126, v126
  v_rcp_f32 v127, v127
  v_pk_mul_f32 v[112:113], v[112:113], v[120:121]
  v_pk_mul_f32 v[114:115], v[114:115], v[122:123]
  v_pk_mul_f32 v[116:117], v[116:117], v[124:125]
  v_pk_mul_f32 v[118:119], v[118:119], v[126:127]
  v_cvt_pk_bf16_f32 v136, v112, v113
  v_cvt_pk_bf16_f32 v137, v114, v115
  v_cvt_pk_bf16_f32 v138, v116, v117
  v_cvt_pk_bf16_f32 v139, v118, v119
  buffer_store_dwordx4 v[136:139], v7, s[44:47], s17 offen offset:1024 sc1
  ds_write_b128 v38, v[136:139] offset:1024
  s_add_u32 s17, s17, 2048
  v_pk_add_f32 v[112:113], v[68:69], v[20:21]
  v_pk_add_f32 v[114:115], v[70:71], v[22:23]
  v_pk_add_f32 v[116:117], v[80:81], v[24:25]
  v_pk_add_f32 v[118:119], v[82:83], v[26:27]
  v_pk_mul_f32 v[120:121], v[112:113], v[112:113]
  v_pk_mul_f32 v[122:123], v[114:115], v[114:115]
  v_pk_mul_f32 v[124:125], v[116:117], v[116:117]
  v_pk_mul_f32 v[126:127], v[118:119], v[118:119]
  v_pk_fma_f32 v[120:121], v[120:121], s[48:49], v[36:37]
  v_pk_fma_f32 v[122:123], v[122:123], s[48:49], v[36:37]
  v_pk_fma_f32 v[124:125], v[124:125], s[48:49], v[36:37]
  v_pk_fma_f32 v[126:127], v[126:127], s[48:49], v[36:37]
  v_pk_mul_f32 v[120:121], v[120:121], v[112:113]
  v_pk_mul_f32 v[122:123], v[122:123], v[114:115]
  v_pk_mul_f32 v[124:125], v[124:125], v[116:117]
  v_pk_mul_f32 v[126:127], v[126:127], v[118:119]
  v_exp_f32 v120, v120
  v_exp_f32 v121, v121
  v_exp_f32 v122, v122
  v_exp_f32 v123, v123
  v_exp_f32 v124, v124
  v_exp_f32 v125, v125
  v_exp_f32 v126, v126
  v_exp_f32 v127, v127
  v_pk_add_f32 v[120:121], v[120:121], 1.0 op_sel_hi:[1,0]
  v_pk_add_f32 v[122:123], v[122:123], 1.0 op_sel_hi:[1,0]
  v_pk_add_f32 v[124:125], v[124:125], 1.0 op_sel_hi:[1,0]
  v_pk_add_f32 v[126:127], v[126:127], 1.0 op_sel_hi:[1,0]
  v_rcp_f32 v120, v120
  v_rcp_f32 v121, v121
  v_rcp_f32 v122, v122
  v_rcp_f32 v123, v123
  v_rcp_f32 v124, v124
  v_rcp_f32 v125, v125
  v_rcp_f32 v126, v126
  v_rcp_f32 v127, v127
  v_pk_mul_f32 v[112:113], v[112:113], v[120:121]
  v_pk_mul_f32 v[114:115], v[114:115], v[122:123]
  v_pk_mul_f32 v[116:117], v[116:117], v[124:125]
  v_pk_mul_f32 v[118:119], v[118:119], v[126:127]
  v_cvt_pk_bf16_f32 v132, v112, v113
  v_cvt_pk_bf16_f32 v133, v114, v115
  v_cvt_pk_bf16_f32 v134, v116, v117
  v_cvt_pk_bf16_f32 v135, v118, v119
  buffer_store_dwordx4 v[132:135], v7, s[44:47], s17 offen offset:0 sc1
  ds_write_b128 v38, v[132:135] offset:2048
  v_pk_add_f32 v[112:113], v[92:93], v[28:29]
  v_pk_add_f32 v[114:115], v[94:95], v[30:31]
  v_pk_add_f32 v[116:117], v[104:105], v[32:33]
  v_pk_add_f32 v[118:119], v[106:107], v[34:35]
  v_pk_mul_f32 v[120:121], v[112:113], v[112:113]
  v_pk_mul_f32 v[122:123], v[114:115], v[114:115]
  v_pk_mul_f32 v[124:125], v[116:117], v[116:117]
  v_pk_mul_f32 v[126:127], v[118:119], v[118:119]
  v_pk_fma_f32 v[120:121], v[120:121], s[48:49], v[36:37]
  v_pk_fma_f32 v[122:123], v[122:123], s[48:49], v[36:37]
  v_pk_fma_f32 v[124:125], v[124:125], s[48:49], v[36:37]
  v_pk_fma_f32 v[126:127], v[126:127], s[48:49], v[36:37]
  v_pk_mul_f32 v[120:121], v[120:121], v[112:113]
  v_pk_mul_f32 v[122:123], v[122:123], v[114:115]
  v_pk_mul_f32 v[124:125], v[124:125], v[116:117]
  v_pk_mul_f32 v[126:127], v[126:127], v[118:119]
  v_exp_f32 v120, v120
  v_exp_f32 v121, v121
  v_exp_f32 v122, v122
  v_exp_f32 v123, v123
  v_exp_f32 v124, v124
  v_exp_f32 v125, v125
  v_exp_f32 v126, v126
  v_exp_f32 v127, v127
  v_pk_add_f32 v[120:121], v[120:121], 1.0 op_sel_hi:[1,0]
  v_pk_add_f32 v[122:123], v[122:123], 1.0 op_sel_hi:[1,0]
  v_pk_add_f32 v[124:125], v[124:125], 1.0 op_sel_hi:[1,0]
  v_pk_add_f32 v[126:127], v[126:127], 1.0 op_sel_hi:[1,0]
  v_rcp_f32 v120, v120
  v_rcp_f32 v121, v121
  v_rcp_f32 v122, v122
  v_rcp_f32 v123, v123
  v_rcp_f32 v124, v124
  v_rcp_f32 v125, v125
  v_rcp_f32 v126, v126
  v_rcp_f32 v127, v127
  v_pk_mul_f32 v[112:113], v[112:113], v[120:121]
  v_pk_mul_f32 v[114:115], v[114:115], v[122:123]
  v_pk_mul_f32 v[116:117], v[116:117], v[124:125]
  v_pk_mul_f32 v[118:119], v[118:119], v[126:127]
  v_cvt_pk_bf16_f32 v136, v112, v113
  v_cvt_pk_bf16_f32 v137, v114, v115
  v_cvt_pk_bf16_f32 v138, v116, v117
  v_cvt_pk_bf16_f32 v139, v118, v119
  buffer_store_dwordx4 v[136:139], v7, s[44:47], s17 offen offset:1024 sc1
  ds_write_b128 v38, v[136:139] offset:3072
  s_add_u32 s17, s17, 2048
  v_pk_add_f32 v[112:113], v[72:73], v[20:21]
  v_pk_add_f32 v[114:115], v[74:75], v[22:23]
  v_pk_add_f32 v[116:117], v[84:85], v[24:25]
  v_pk_add_f32 v[118:119], v[86:87], v[26:27]
  v_pk_mul_f32 v[120:121], v[112:113], v[112:113]
  v_pk_mul_f32 v[122:123], v[114:115], v[114:115]
  v_pk_mul_f32 v[124:125], v[116:117], v[116:117]
  v_pk_mul_f32 v[126:127], v[118:119], v[118:119]
  v_pk_fma_f32 v[120:121], v[120:121], s[48:49], v[36:37]
  v_pk_fma_f32 v[122:123], v[122:123], s[48:49], v[36:37]
  v_pk_fma_f32 v[124:125], v[124:125], s[48:49], v[36:37]
  v_pk_fma_f32 v[126:127], v[126:127], s[48:49], v[36:37]
  v_pk_mul_f32 v[120:121], v[120:121], v[112:113]
  v_pk_mul_f32 v[122:123], v[122:123], v[114:115]
  v_pk_mul_f32 v[124:125], v[124:125], v[116:117]
  v_pk_mul_f32 v[126:127], v[126:127], v[118:119]
  v_exp_f32 v120, v120
  v_exp_f32 v121, v121
  v_exp_f32 v122, v122
  v_exp_f32 v123, v123
  v_exp_f32 v124, v124
  v_exp_f32 v125, v125
  v_exp_f32 v126, v126
  v_exp_f32 v127, v127
  v_pk_add_f32 v[120:121], v[120:121], 1.0 op_sel_hi:[1,0]
  v_pk_add_f32 v[122:123], v[122:123], 1.0 op_sel_hi:[1,0]
  v_pk_add_f32 v[124:125], v[124:125], 1.0 op_sel_hi:[1,0]
  v_pk_add_f32 v[126:127], v[126:127], 1.0 op_sel_hi:[1,0]
  v_rcp_f32 v120, v120
  v_rcp_f32 v121, v121
  v_rcp_f32 v122, v122
  v_rcp_f32 v123, v123
  v_rcp_f32 v124, v124
  v_rcp_f32 v125, v125
  v_rcp_f32 v126, v126
  v_rcp_f32 v127, v127
  v_pk_mul_f32 v[112:113], v[112:113], v[120:121]
  v_pk_mul_f32 v[114:115], v[114:115], v[122:123]
  v_pk_mul_f32 v[116:117], v[116:117], v[124:125]
  v_pk_mul_f32 v[118:119], v[118:119], v[126:127]
  v_cvt_pk_bf16_f32 v132, v112, v113
  v_cvt_pk_bf16_f32 v133, v114, v115
  v_cvt_pk_bf16_f32 v134, v116, v117
  v_cvt_pk_bf16_f32 v135, v118, v119
  buffer_store_dwordx4 v[132:135], v7, s[44:47], s17 offen offset:0 sc1
  ds_write_b128 v38, v[132:135] offset:4096
  v_pk_add_f32 v[112:113], v[96:97], v[28:29]
  v_pk_add_f32 v[114:115], v[98:99], v[30:31]
  v_pk_add_f32 v[116:117], v[108:109], v[32:33]
  v_pk_add_f32 v[118:119], v[110:111], v[34:35]
  v_pk_mul_f32 v[120:121], v[112:113], v[112:113]
  v_pk_mul_f32 v[122:123], v[114:115], v[114:115]
  v_pk_mul_f32 v[124:125], v[116:117], v[116:117]
  v_pk_mul_f32 v[126:127], v[118:119], v[118:119]
  v_pk_fma_f32 v[120:121], v[120:121], s[48:49], v[36:37]
  v_pk_fma_f32 v[122:123], v[122:123], s[48:49], v[36:37]
  v_pk_fma_f32 v[124:125], v[124:125], s[48:49], v[36:37]
  v_pk_fma_f32 v[126:127], v[126:127], s[48:49], v[36:37]
  v_pk_mul_f32 v[120:121], v[120:121], v[112:113]
  v_pk_mul_f32 v[122:123], v[122:123], v[114:115]
  v_pk_mul_f32 v[124:125], v[124:125], v[116:117]
  v_pk_mul_f32 v[126:127], v[126:127], v[118:119]
  v_exp_f32 v120, v120
  v_exp_f32 v121, v121
  v_exp_f32 v122, v122
  v_exp_f32 v123, v123
  v_exp_f32 v124, v124
  v_exp_f32 v125, v125
  v_exp_f32 v126, v126
  v_exp_f32 v127, v127
  v_pk_add_f32 v[120:121], v[120:121], 1.0 op_sel_hi:[1,0]
  v_pk_add_f32 v[122:123], v[122:123], 1.0 op_sel_hi:[1,0]
  v_pk_add_f32 v[124:125], v[124:125], 1.0 op_sel_hi:[1,0]
  v_pk_add_f32 v[126:127], v[126:127], 1.0 op_sel_hi:[1,0]
  v_rcp_f32 v120, v120
  v_rcp_f32 v121, v121
  v_rcp_f32 v122, v122
  v_rcp_f32 v123, v123
  v_rcp_f32 v124, v124
  v_rcp_f32 v125, v125
  v_rcp_f32 v126, v126
  v_rcp_f32 v127, v127
  v_pk_mul_f32 v[112:113], v[112:113], v[120:121]
  v_pk_mul_f32 v[114:115], v[114:115], v[122:123]
  v_pk_mul_f32 v[116:117], v[116:117], v[124:125]
  v_pk_mul_f32 v[118:119], v[118:119], v[126:127]
  v_cvt_pk_bf16_f32 v136, v112, v113
  v_cvt_pk_bf16_f32 v137, v114, v115
  v_cvt_pk_bf16_f32 v138, v116, v117
  v_cvt_pk_bf16_f32 v139, v118, v119
  buffer_store_dwordx4 v[136:139], v7, s[44:47], s17 offen offset:1024 sc1
  ds_write_b128 v38, v[136:139] offset:5120
  s_add_u32 s17, s17, 2048
  s_cmp_ge_u32 s2, 192
  s_cbranch_scc1 L_m_conv1
  s_lshr_b32 s13, s2, 3
  s_mul_i32 s12, s13, 10923
  s_lshr_b32 s12, s12, 16
  s_mul_i32 s15, s12, 6
  s_sub_u32 s15, s13, s15
  s_bfe_u32 s19, s2, 0x10002
  s_and_b32 s13, s2, 3
  s_lshl_b32 s14, s13, 2
  s_add_u32 s14, s14, s12
  s_mul_i32 s13, s13, 9
  s_add_u32 s13, s13, 1
  s_lshr_b32 s13, s13, 1
  s_lshl_b32 s16, s14, 7
  s_lshl_b32 s17, s19, 6
  s_add_u32 s16, s16, s17
  v_bfe_u32 v4, v1, 2, 2
  v_lshl_add_u32 v5, v3, 2, v4
  v_and_b32 v6, 7, v5
  v_lshlrev_b32 v5, 8, v5
  v_and_b32 v8, 3, v1
  v_lshl_add_u32 v5, v8, 3, v5
  s_and_b32 s26, s20, 2
  s_lshl_b32 s27, s19, 2
  s_add_u32 s26, s26, s27
  s_add_u32 s27, s26, 0
  s_xor_b32 s27, s27, 0
  v_xor_b32 v8, s27, v6
  v_lshl_add_u32 v48, v8, 5, v5
  v_add_u32 v52, 57344, v48
  s_add_u32 s27, s26, 1
  s_xor_b32 s27, s27, 0
  v_xor_b32 v8, s27, v6
  v_lshl_add_u32 v49, v8, 5, v5
  v_add_u32 v53, 57344, v49
  s_add_u32 s27, s26, 0
  s_xor_b32 s27, s27, 4
  v_xor_b32 v8, s27, v6
  v_lshl_add_u32 v50, v8, 5, v5
  v_add_u32 v54, 57344, v50
  s_add_u32 s27, s26, 1
  s_xor_b32 s27, s27, 4
  v_xor_b32 v8, s27, v6
  v_lshl_add_u32 v51, v8, 5, v5
  v_add_u32 v55, 57344, v51
  s_and_b32 s26, s20, 1
  s_mul_i32 s26, s26, 6144
  s_add_u32 s26, s26, 16384
  v_add_u32 v56, s26, v7
  v_add_u32 v57, 57344, v56
  s_mov_b32 s32, s6
  s_mov_b32 s33, s7
  s_mov_b32 s34, 0x240000
  s_mov_b32 s35, 0x20000
  s_mov_b32 s28, s52
  s_mov_b32 s29, s53
  s_mov_b32 s30, 0x1000
  s_mov_b32 s31, 0x20000
  s_lshr_b32 s17, s20, 1
  s_lshl_b32 s17, s17, 5
  s_add_u32 s17, s17, s16
  s_mul_i32 s18, s15, 96
  s_and_b32 s26, s20, 1
  s_mul_i32 s26, s26, 48
  s_add_u32 s18, s18, s26
  v_mul_u32_u24 v58, 1152, v2
  v_lshl_add_u32 v58, v3, 3, v58
  v_lshlrev_b32 v9, 1, v2
  s_mul_i32 s56, s17, 1152
  s_lshl_b32 s26, s18, 1
  s_add_u32 s56, s56, s26
  s_add_u32 s57, s56, 18432
  s_lshl_b32 s26, s17, 1
  s_mov_b32 s22, s26
  v_mov_b32 v39, v58
  v_mov_b32 v64, 0
  v_mov_b32 v65, 0
  v_mov_b32 v66, 0
  v_mov_b32 v67, 0
  v_mov_b32 v68, 0
  v_mov_b32 v69, 0
  v_mov_b32 v70, 0
  v_mov_b32 v71, 0
  v_mov_b32 v72, 0
  v_mov_b32 v73, 0
  v_mov_b32 v74, 0
  v_mov_b32 v75, 0
  v_mov_b32 v76, 0
  v_mov_b32 v77, 0
  v_mov_b32 v78, 0
  v_mov_b32 v79, 0
  v_mov_b32 v80, 0
  v_mov_b32 v81, 0
  v_mov_b32 v82, 0
  v_mov_b32 v83, 0
  v_mov_b32 v84, 0
  v_mov_b32 v85, 0
  v_mov_b32 v86, 0
  v_mov_b32 v87, 0
  v_mov_b32 v88, 0
  v_mov_b32 v89, 0
  v_mov_b32 v90, 0
  v_mov_b32 v91, 0
  v_mov_b32 v92, 0
  v_mov_b32 v93, 0
  v_mov_b32 v94, 0
  v_mov_b32 v95, 0
  v_mov_b32 v96, 0
  v_mov_b32 v97, 0
  v_mov_b32 v98, 0
  v_mov_b32 v99, 0
  v_mov_b32 v100, 0
  v_mov_b32 v101, 0
  v_mov_b32 v102, 0
  v_mov_b32 v103, 0
  v_mov_b32 v104, 0
  v_mov_b32 v105, 0
  v_mov_b32 v106, 0
  v_mov_b32 v107, 0
  v_mov_b32 v108, 0
  v_mov_b32 v109, 0
  v_mov_b32 v110, 0
  v_mov_b32 v111, 0
  v_bfe_u32 v4, v1, 2, 2
  v_lshl_add_u32 v4, v3, 2, v4
  v_lshlrev_b32 v4, 7, v4
  v_and_b32 v5, 3, v1
  v_lshl_add_u32 v4, v5, 3, v4
  s_and_b32 s26, s20, 1
  s_mul_i32 s26, s26, 6144
  s_lshr_b32 s27, s20, 1
  s_lshl_b32 s27, s27, 6
  s_add_u32 s26, s26, s27
  s_add_u32 s26, s26, 114688
  v_add_u32 v59, s26, v4
  v_mov_b32 v31, v59
  s_xor_b32 s58, s2, 4
  s_lshl_b32 s26, s20, 12
  s_lshl_b32 s59, s58, 14
  s_add_u32 s59, s59, s26
  s_lshl_b32 s60, s2, 14
  s_add_u32 s60, s60, s26
  s_add_u32 s8, s4, 0xc10000
  s_addc_u32 s9, s5, 0
  s_mov_b32 s10, 0x300000
  s_mov_b32 s11, 0x20000
  s_waitcnt vmcnt(0)
  v_mov_b32 v58, 158728
  v_mov_b32 v59, 1
  v_mov_b32 v61, 0
  s_mov_b64 exec, 1
  ds_add_rtn_u32 v60, v58, v59
  s_waitcnt lgkmcnt(0)
  v_readfirstlane_b32 s23, v60
  s_nop 0
  s_cmp_lg_u32 s23, 3
  s_cbranch_scc1 L_gd2_notlast
  v_mov_b32 v59, s101
  buffer_store_dword v59, v61, s[40:43], s24 offen sc1
L_gd2_notlast:
  s_mov_b64 exec, -1
  s_waitcnt lgkmcnt(0)
  s_barrier
  ds_read_b128 v[128:131], v56 offset:0
  ds_read_b64_tr_b16 v[112:113], v48 offset:0
  ds_read_b64_tr_b16 v[114:115], v48 offset:4096
  ds_read_b128 v[132:135], v56 offset:2048
  ds_read_b128 v[136:139], v56 offset:4096
  ds_read_b64_tr_b16 v[116:117], v49 offset:0
  ds_read_b64_tr_b16 v[118:119], v49 offset:4096
  ds_read_b64_tr_b16 v[120:121], v50 offset:0
  ds_read_b64_tr_b16 v[122:123], v50 offset:4096
  ds_read_b64_tr_b16 v[124:125], v51 offset:0
  ds_read_b64_tr_b16 v[126:127], v51 offset:4096
  s_mov_b32 s25, 8
.p2align 6
L_g2_loop:
  s_waitcnt lgkmcnt(6)
  v_mfma_f32_16x16x32_bf16 v[64:67], v[128:131], v[112:115], v[64:67]
  ds_read_b128 v[156:159], v56 offset:1024
  ds_read_b64_tr_b16 v[140:141], v48 offset:8192
  v_mfma_f32_16x16x32_bf16 v[68:71], v[132:135], v[112:115], v[68:71]
  ds_read_b64_tr_b16 v[142:143], v48 offset:12288
  ds_read_b128 v[160:163], v56 offset:3072
  v_mfma_f32_16x16x32_bf16 v[72:75], v[136:139], v[112:115], v[72:75]
  s_waitcnt lgkmcnt(8)
  ds_read_b128 v[164:167], v56 offset:5120
  v_mfma_f32_16x16x32_bf16 v[84:87], v[136:139], v[116:119], v[84:87]
  ds_read_b64_tr_b16 v[144:145], v49 offset:8192
  ds_read_b64_tr_b16 v[146:147], v49 offset:12288
  v_mfma_f32_16x16x32_bf16 v[80:83], v[132:135], v[116:119], v[80:83]
  ds_read_b64_tr_b16 v[148:149], v50 offset:8192
  ds_read_b64_tr_b16 v[150:151], v50 offset:12288
  v_mfma_f32_16x16x32_bf16 v[76:79], v[128:131], v[116:119], v[76:79]
  s_waitcnt lgkmcnt(9)
  ds_read_b64_tr_b16 v[152:153], v51 offset:8192
  v_mfma_f32_16x16x32_bf16 v[88:91], v[128:131], v[120:123], v[88:91]
  ds_read_b64_tr_b16 v[154:155], v51 offset:12288
  v_mfma_f32_16x16x32_bf16 v[92:95], v[132:135], v[120:123], v[92:95]
  v_mfma_f32_16x16x32_bf16 v[96:99], v[136:139], v[120:123], v[96:99]
  v_mfma_f32_16x16x32_bf16 v[108:111], v[136:139], v[124:127], v[108:111]
  v_mfma_f32_16x16x32_bf16 v[104:107], v[132:135], v[124:127], v[104:107]
  v_mfma_f32_16x16x32_bf16 v[100:103], v[128:131], v[124:127], v[100:103]
  s_waitcnt lgkmcnt(0)
  s_barrier
  v_mfma_f32_16x16x32_bf16 v[64:67], v[156:159], v[140:143], v[64:67]
  ds_read_b128 v[128:131], v56 offset:28672
  ds_read_b64_tr_b16 v[112:113], v48 offset:28672
  v_mfma_f32_16x16x32_bf16 v[68:71], v[160:163], v[140:143], v[68:71]
  ds_read_b64_tr_b16 v[114:115], v48 offset:32768
  ds_read_b128 v[132:135], v56 offset:30720
  v_mfma_f32_16x16x32_bf16 v[72:75], v[164:167], v[140:143], v[72:75]
  ds_read_b128 v[136:139], v56 offset:32768
  ds_read_b64_tr_b16 v[116:117], v49 offset:28672
  v_mfma_f32_16x16x32_bf16 v[84:87], v[164:167], v[144:147], v[84:87]
  ds_read_b64_tr_b16 v[118:119], v49 offset:32768
  ds_read_b64_tr_b16 v[120:121], v50 offset:28672
  v_mfma_f32_16x16x32_bf16 v[80:83], v[160:163], v[144:147], v[80:83]
  ds_read_b64_tr_b16 v[122:123], v50 offset:32768
  ds_read_b64_tr_b16 v[124:125], v51 offset:28672
  v_mfma_f32_16x16x32_bf16 v[76:79], v[156:159], v[144:147], v[76:79]
  ds_read_b64_tr_b16 v[126:127], v51 offset:32768
  v_mfma_f32_16x16x32_bf16 v[88:91], v[156:159], v[148:151], v[88:91]
  v_mfma_f32_16x16x32_bf16 v[92:95], v[160:163], v[148:151], v[92:95]
  v_mfma_f32_16x16x32_bf16 v[96:99], v[164:167], v[148:151], v[96:99]
  v_mfma_f32_16x16x32_bf16 v[108:111], v[164:167], v[152:155], v[108:111]
  v_mfma_f32_16x16x32_bf16 v[104:107], v[160:163], v[152:155], v[104:107]
  v_mfma_f32_16x16x32_bf16 v[100:103], v[156:159], v[152:155], v[100:103]
  s_waitcnt lgkmcnt(6)
  v_mfma_f32_16x16x32_bf16 v[64:67], v[128:131], v[112:115], v[64:67]
  ds_read_b128 v[156:159], v56 offset:29696
  ds_read_b64_tr_b16 v[140:141], v48 offset:36864
  v_mfma_f32_16x16x32_bf16 v[68:71], v[132:135], v[112:115], v[68:71]
  ds_read_b64_tr_b16 v[142:143], v48 offset:40960
  ds_read_b128 v[160:163], v56 offset:31744
  v_mfma_f32_16x16x32_bf16 v[72:75], v[136:139], v[112:115], v[72:75]
  s_waitcnt lgkmcnt(8)
  ds_read_b128 v[164:167], v56 offset:33792
  v_mfma_f32_16x16x32_bf16 v[84:87], v[136:139], v[116:119], v[84:87]
  ds_read_b64_tr_b16 v[144:145], v49 offset:36864
  ds_read_b64_tr_b16 v[146:147], v49 offset:40960
  v_mfma_f32_16x16x32_bf16 v[80:83], v[132:135], v[116:119], v[80:83]
  ds_read_b64_tr_b16 v[148:149], v50 offset:36864
  ds_read_b64_tr_b16 v[150:151], v50 offset:40960
  v_mfma_f32_16x16x32_bf16 v[76:79], v[128:131], v[116:119], v[76:79]
  s_waitcnt lgkmcnt(9)
  ds_read_b64_tr_b16 v[152:153], v51 offset:36864
  v_mfma_f32_16x16x32_bf16 v[88:91], v[128:131], v[120:123], v[88:91]
  ds_read_b64_tr_b16 v[154:155], v51 offset:40960
  v_mfma_f32_16x16x32_bf16 v[92:95], v[132:135], v[120:123], v[92:95]
  v_mfma_f32_16x16x32_bf16 v[96:99], v[136:139], v[120:123], v[96:99]
  v_mfma_f32_16x16x32_bf16 v[108:111], v[136:139], v[124:127], v[108:111]
  v_mfma_f32_16x16x32_bf16 v[104:107], v[132:135], v[124:127], v[104:107]
  v_mfma_f32_16x16x32_bf16 v[100:103], v[128:131], v[124:127], v[100:103]
  s_waitcnt lgkmcnt(0)
  s_barrier
  v_mfma_f32_16x16x32_bf16 v[64:67], v[156:159], v[140:143], v[64:67]
  ds_read_b128 v[128:131], v57 offset:0
  ds_read_b64_tr_b16 v[112:113], v52 offset:0
  v_mfma_f32_16x16x32_bf16 v[68:71], v[160:163], v[140:143], v[68:71]
  ds_read_b64_tr_b16 v[114:115], v52 offset:4096
  ds_read_b128 v[132:135], v57 offset:2048
  v_mfma_f32_16x16x32_bf16 v[72:75], v[164:167], v[140:143], v[72:75]
  ds_read_b128 v[136:139], v57 offset:4096
  ds_read_b64_tr_b16 v[116:117], v53 offset:0
  v_mfma_f32_16x16x32_bf16 v[84:87], v[164:167], v[144:147], v[84:87]
  ds_read_b64_tr_b16 v[118:119], v53 offset:4096
  ds_read_b64_tr_b16 v[120:121], v54 offset:0
  v_mfma_f32_16x16x32_bf16 v[80:83], v[160:163], v[144:147], v[80:83]
  ds_read_b64_tr_b16 v[122:123], v54 offset:4096
  ds_read_b64_tr_b16 v[124:125], v55 offset:0
  v_mfma_f32_16x16x32_bf16 v[76:79], v[156:159], v[144:147], v[76:79]
  ds_read_b64_tr_b16 v[126:127], v55 offset:4096
  v_mfma_f32_16x16x32_bf16 v[88:91], v[156:159], v[148:151], v[88:91]
  v_mfma_f32_16x16x32_bf16 v[92:95], v[160:163], v[148:151], v[92:95]
  v_mfma_f32_16x16x32_bf16 v[96:99], v[164:167], v[148:151], v[96:99]
  v_mfma_f32_16x16x32_bf16 v[108:111], v[164:167], v[152:155], v[108:111]
  v_mfma_f32_16x16x32_bf16 v[104:107], v[160:163], v[152:155], v[104:107]
  v_mfma_f32_16x16x32_bf16 v[100:103], v[156:159], v[152:155], v[100:103]
  s_waitcnt lgkmcnt(6)
  v_mfma_f32_16x16x32_bf16 v[64:67], v[128:131], v[112:115], v[64:67]
  ds_read_b128 v[156:159], v57 offset:1024
  ds_read_b64_tr_b16 v[140:141], v52 offset:8192
  v_mfma_f32_16x16x32_bf16 v[68:71], v[132:135], v[112:115], v[68:71]
  ds_read_b64_tr_b16 v[142:143], v52 offset:12288
  ds_read_b128 v[160:163], v57 offset:3072
  v_mfma_f32_16x16x32_bf16 v[72:75], v[136:139], v[112:115], v[72:75]
  s_waitcnt lgkmcnt(8)
  ds_read_b128 v[164:167], v57 offset:5120
  v_mfma_f32_16x16x32_bf16 v[84:87], v[136:139], v[116:119], v[84:87]
  ds_read_b64_tr_b16 v[144:145], v53 offset:8192
  ds_read_b64_tr_b16 v[146:147], v53 offset:12288
  v_mfma_f32_16x16x32_bf16 v[80:83], v[132:135], v[116:119], v[80:83]
  ds_read_b64_tr_b16 v[148:149], v54 offset:8192
  ds_read_b64_tr_b16 v[150:151], v54 offset:12288
  v_mfma_f32_16x16x32_bf16 v[76:79], v[128:131], v[116:119], v[76:79]
  s_waitcnt lgkmcnt(9)
  ds_read_b64_tr_b16 v[152:153], v55 offset:8192
  v_mfma_f32_16x16x32_bf16 v[88:91], v[128:131], v[120:123], v[88:91]
  ds_read_b64_tr_b16 v[154:155], v55 offset:12288
  v_mfma_f32_16x16x32_bf16 v[92:95], v[132:135], v[120:123], v[92:95]
  v_mfma_f32_16x16x32_bf16 v[96:99], v[136:139], v[120:123], v[96:99]
  v_mfma_f32_16x16x32_bf16 v[108:111], v[136:139], v[124:127], v[108:111]
  v_mfma_f32_16x16x32_bf16 v[104:107], v[132:135], v[124:127], v[104:107]
  v_mfma_f32_16x16x32_bf16 v[100:103], v[128:131], v[124:127], v[100:103]
  s_waitcnt lgkmcnt(0)
  s_barrier
  v_mfma_f32_16x16x32_bf16 v[64:67], v[156:159], v[140:143], v[64:67]
  ds_read_b128 v[128:131], v57 offset:28672
  ds_read_b64_tr_b16 v[112:113], v52 offset:28672
  v_mfma_f32_16x16x32_bf16 v[68:71], v[160:163], v[140:143], v[68:71]
  ds_read_b64_tr_b16 v[114:115], v52 offset:32768
  ds_read_b128 v[132:135], v57 offset:30720
  v_mfma_f32_16x16x32_bf16 v[72:75], v[164:167], v[140:143], v[72:75]
  ds_read_b128 v[136:139], v57 offset:32768
  ds_read_b64_tr_b16 v[116:117], v53 offset:28672
  v_mfma_f32_16x16x32_bf16 v[84:87], v[164:167], v[144:147], v[84:87]
  ds_read_b64_tr_b16 v[118:119], v53 offset:32768
  ds_read_b64_tr_b16 v[120:121], v54 offset:28672
  v_mfma_f32_16x16x32_bf16 v[80:83], v[160:163], v[144:147], v[80:83]
  ds_read_b64_tr_b16 v[122:123], v54 offset:32768
  ds_read_b64_tr_b16 v[124:125], v55 offset:28672
  v_mfma_f32_16x16x32_bf16 v[76:79], v[156:159], v[144:147], v[76:79]
  ds_read_b64_tr_b16 v[126:127], v55 offset:32768
  v_mfma_f32_16x16x32_bf16 v[88:91], v[156:159], v[148:151], v[88:91]
  v_mfma_f32_16x16x32_bf16 v[92:95], v[160:163], v[148:151], v[92:95]
  v_mfma_f32_16x16x32_bf16 v[96:99], v[164:167], v[148:151], v[96:99]
  v_mfma_f32_16x16x32_bf16 v[108:111], v[164:167], v[152:155], v[108:111]
  v_mfma_f32_16x16x32_bf16 v[104:107], v[160:163], v[152:155], v[104:107]
  v_mfma_f32_16x16x32_bf16 v[100:103], v[156:159], v[152:155], v[100:103]
  s_waitcnt lgkmcnt(6)
  v_mfma_f32_16x16x32_bf16 v[64:67], v[128:131], v[112:115], v[64:67]
  ds_read_b128 v[156:159], v57 offset:29696
  ds_read_b64_tr_b16 v[140:141], v52 offset:36864
  v_mfma_f32_16x16x32_bf16 v[68:71], v[132:135], v[112:115], v[68:71]
  ds_read_b64_tr_b16 v[142:143], v52 offset:40960
  ds_read_b128 v[160:163], v57 offset:31744
  v_mfma_f32_16x16x32_bf16 v[72:75], v[136:139], v[112:115], v[72:75]
  s_waitcnt lgkmcnt(8)
  ds_read_b128 v[164:167], v57 offset:33792
  v_mfma_f32_16x16x32_bf16 v[84:87], v[136:139], v[116:119], v[84:87]
  ds_read_b64_tr_b16 v[144:145], v53 offset:36864
  ds_read_b64_tr_b16 v[146:147], v53 offset:40960
  v_mfma_f32_16x16x32_bf16 v[80:83], v[132:135], v[116:119], v[80:83]
  ds_read_b64_tr_b16 v[148:149], v54 offset:36864
  ds_read_b64_tr_b16 v[150:151], v54 offset:40960
  v_mfma_f32_16x16x32_bf16 v[76:79], v[128:131], v[116:119], v[76:79]
  s_waitcnt lgkmcnt(9)
  ds_read_b64_tr_b16 v[152:153], v55 offset:36864
  v_mfma_f32_16x16x32_bf16 v[88:91], v[128:131], v[120:123], v[88:91]
  ds_read_b64_tr_b16 v[154:155], v55 offset:40960
  v_mfma_f32_16x16x32_bf16 v[92:95], v[132:135], v[120:123], v[92:95]
  v_mfma_f32_16x16x32_bf16 v[96:99], v[136:139], v[120:123], v[96:99]
  v_mfma_f32_16x16x32_bf16 v[108:111], v[136:139], v[124:127], v[108:111]
  v_mfma_f32_16x16x32_bf16 v[104:107], v[132:135], v[124:127], v[104:107]
  v_mfma_f32_16x16x32_bf16 v[100:103], v[128:131], v[124:127], v[100:103]
  s_waitcnt lgkmcnt(0)
  s_barrier
  v_mfma_f32_16x16x32_bf16 v[64:67], v[156:159], v[140:143], v[64:67]
  ds_read_b128 v[128:131], v56 offset:0
  ds_read_b64_tr_b16 v[112:113], v48 offset:0
  v_mfma_f32_16x16x32_bf16 v[68:71], v[160:163], v[140:143], v[68:71]
  ds_read_b64_tr_b16 v[114:115], v48 offset:4096
  ds_read_b128 v[132:135], v56 offset:2048
  v_mfma_f32_16x16x32_bf16 v[72:75], v[164:167], v[140:143], v[72:75]
  ds_read_b128 v[136:139], v56 offset:4096
  ds_read_b64_tr_b16 v[116:117], v49 offset:0
  v_mfma_f32_16x16x32_bf16 v[84:87], v[164:167], v[144:147], v[84:87]
  ds_read_b64_tr_b16 v[118:119], v49 offset:4096
  ds_read_b64_tr_b16 v[120:121], v50 offset:0
  v_mfma_f32_16x16x32_bf16 v[80:83], v[160:163], v[144:147], v[80:83]
  ds_read_b64_tr_b16 v[122:123], v50 offset:4096
  ds_read_b64_tr_b16 v[124:125], v51 offset:0
  v_mfma_f32_16x16x32_bf16 v[76:79], v[156:159], v[144:147], v[76:79]
  ds_read_b64_tr_b16 v[126:127], v51 offset:4096
  v_mfma_f32_16x16x32_bf16 v[88:91], v[156:159], v[148:151], v[88:91]
  v_mfma_f32_16x16x32_bf16 v[92:95], v[160:163], v[148:151], v[92:95]
  v_mfma_f32_16x16x32_bf16 v[96:99], v[164:167], v[148:151], v[96:99]
  v_mfma_f32_16x16x32_bf16 v[108:111], v[164:167], v[152:155], v[108:111]
  v_mfma_f32_16x16x32_bf16 v[104:107], v[160:163], v[152:155], v[104:107]
  v_mfma_f32_16x16x32_bf16 v[100:103], v[156:159], v[152:155], v[100:103]
  s_sub_u32 s25, s25, 1
  s_cmp_lg_u32 s25, 0
  s_cbranch_scc1 L_g2_loop
  s_waitcnt lgkmcnt(6)
  v_mfma_f32_16x16x32_bf16 v[64:67], v[128:131], v[112:115], v[64:67]
  ds_read_b128 v[156:159], v56 offset:1024
  ds_read_b64_tr_b16 v[140:141], v48 offset:8192
  v_mfma_f32_16x16x32_bf16 v[68:71], v[132:135], v[112:115], v[68:71]
  ds_read_b64_tr_b16 v[142:143], v48 offset:12288
  ds_read_b128 v[160:163], v56 offset:3072
  v_mfma_f32_16x16x32_bf16 v[72:75], v[136:139], v[112:115], v[72:75]
  s_waitcnt lgkmcnt(8)
  ds_read_b128 v[164:167], v56 offset:5120
  v_mfma_f32_16x16x32_bf16 v[84:87], v[136:139], v[116:119], v[84:87]
  ds_read_b64_tr_b16 v[144:145], v49 offset:8192
  ds_read_b64_tr_b16 v[146:147], v49 offset:12288
  v_mfma_f32_16x16x32_bf16 v[80:83], v[132:135], v[116:119], v[80:83]
  ds_read_b64_tr_b16 v[148:149], v50 offset:8192
  ds_read_b64_tr_b16 v[150:151], v50 offset:12288
  v_mfma_f32_16x16x32_bf16 v[76:79], v[128:131], v[116:119], v[76:79]
  s_waitcnt lgkmcnt(9)
  ds_read_b64_tr_b16 v[152:153], v51 offset:8192
  v_mfma_f32_16x16x32_bf16 v[88:91], v[128:131], v[120:123], v[88:91]
  ds_read_b64_tr_b16 v[154:155], v51 offset:12288
  v_mfma_f32_16x16x32_bf16 v[92:95], v[132:135], v[120:123], v[92:95]
  v_mfma_f32_16x16x32_bf16 v[96:99], v[136:139], v[120:123], v[96:99]
  v_mfma_f32_16x16x32_bf16 v[108:111], v[136:139], v[124:127], v[108:111]
  v_mfma_f32_16x16x32_bf16 v[104:107], v[132:135], v[124:127], v[104:107]
  v_mfma_f32_16x16x32_bf16 v[100:103], v[128:131], v[124:127], v[100:103]
  s_waitcnt lgkmcnt(0)
  s_barrier
  v_mfma_f32_16x16x32_bf16 v[64:67], v[156:159], v[140:143], v[64:67]
  ds_read_b128 v[128:131], v56 offset:28672
  ds_read_b64_tr_b16 v[112:113], v48 offset:28672
  v_mfma_f32_16x16x32_bf16 v[68:71], v[160:163], v[140:143], v[68:71]
  ds_read_b64_tr_b16 v[114:115], v48 offset:32768
  ds_read_b128 v[132:135], v56 offset:30720
  v_mfma_f32_16x16x32_bf16 v[72:75], v[164:167], v[140:143], v[72:75]
  ds_read_b128 v[136:139], v56 offset:32768
  ds_read_b64_tr_b16 v[116:117], v49 offset:28672
  v_mfma_f32_16x16x32_bf16 v[84:87], v[164:167], v[144:147], v[84:87]
  ds_read_b64_tr_b16 v[118:119], v49 offset:32768
  ds_read_b64_tr_b16 v[120:121], v50 offset:28672
  v_mfma_f32_16x16x32_bf16 v[80:83], v[160:163], v[144:147], v[80:83]
  ds_read_b64_tr_b16 v[122:123], v50 offset:32768
  ds_read_b64_tr_b16 v[124:125], v51 offset:28672
  v_mfma_f32_16x16x32_bf16 v[76:79], v[156:159], v[144:147], v[76:79]
  ds_read_b64_tr_b16 v[126:127], v51 offset:32768
  v_mfma_f32_16x16x32_bf16 v[88:91], v[156:159], v[148:151], v[88:91]
  v_mfma_f32_16x16x32_bf16 v[92:95], v[160:163], v[148:151], v[92:95]
  v_mfma_f32_16x16x32_bf16 v[96:99], v[164:167], v[148:151], v[96:99]
  v_mfma_f32_16x16x32_bf16 v[108:111], v[164:167], v[152:155], v[108:111]
  v_mfma_f32_16x16x32_bf16 v[104:107], v[160:163], v[152:155], v[104:107]
  v_mfma_f32_16x16x32_bf16 v[100:103], v[156:159], v[152:155], v[100:103]
  s_waitcnt lgkmcnt(6)
  v_mfma_f32_16x16x32_bf16 v[64:67], v[128:131], v[112:115], v[64:67]
  ds_read_b128 v[156:159], v56 offset:29696
  ds_read_b64_tr_b16 v[140:141], v48 offset:36864
  v_mfma_f32_16x16x32_bf16 v[68:71], v[132:135], v[112:115], v[68:71]
  ds_read_b64_tr_b16 v[142:143], v48 offset:40960
  ds_read_b128 v[160:163], v56 offset:31744
  v_mfma_f32_16x16x32_bf16 v[72:75], v[136:139], v[112:115], v[72:75]
  s_waitcnt lgkmcnt(8)
  ds_read_b128 v[164:167], v56 offset:33792
  v_mfma_f32_16x16x32_bf16 v[84:87], v[136:139], v[116:119], v[84:87]
  ds_read_b64_tr_b16 v[144:145], v49 offset:36864
  ds_read_b64_tr_b16 v[146:147], v49 offset:40960
  v_mfma_f32_16x16x32_bf16 v[80:83], v[132:135], v[116:119], v[80:83]
  ds_read_b64_tr_b16 v[148:149], v50 offset:36864
  ds_read_b64_tr_b16 v[150:151], v50 offset:40960
  v_mfma_f32_16x16x32_bf16 v[76:79], v[128:131], v[116:119], v[76:79]
  s_waitcnt lgkmcnt(9)
  ds_read_b64_tr_b16 v[152:153], v51 offset:36864
  v_mfma_f32_16x16x32_bf16 v[88:91], v[128:131], v[120:123], v[88:91]
  ds_read_b64_tr_b16 v[154:155], v51 offset:40960
  v_mfma_f32_16x16x32_bf16 v[92:95], v[132:135], v[120:123], v[92:95]
  v_mfma_f32_16x16x32_bf16 v[96:99], v[136:139], v[120:123], v[96:99]
  v_mfma_f32_16x16x32_bf16 v[108:111], v[136:139], v[124:127], v[108:111]
  v_mfma_f32_16x16x32_bf16 v[104:107], v[132:135], v[124:127], v[104:107]
  v_mfma_f32_16x16x32_bf16 v[100:103], v[128:131], v[124:127], v[100:103]
  s_waitcnt lgkmcnt(0)
  s_barrier
  v_mfma_f32_16x16x32_bf16 v[64:67], v[156:159], v[140:143], v[64:67]
  ds_read_b128 v[128:131], v57 offset:0
  ds_read_b64_tr_b16 v[112:113], v52 offset:0
  v_mfma_f32_16x16x32_bf16 v[68:71], v[160:163], v[140:143], v[68:71]
  ds_read_b64_tr_b16 v[114:115], v52 offset:4096
  ds_read_b128 v[132:135], v57 offset:2048
  v_mfma_f32_16x16x32_bf16 v[72:75], v[164:167], v[140:143], v[72:75]
  ds_read_b128 v[136:139], v57 offset:4096
  ds_read_b64_tr_b16 v[116:117], v53 offset:0
  v_mfma_f32_16x16x32_bf16 v[84:87], v[164:167], v[144:147], v[84:87]
  ds_read_b64_tr_b16 v[118:119], v53 offset:4096
  ds_read_b64_tr_b16 v[120:121], v54 offset:0
  v_mfma_f32_16x16x32_bf16 v[80:83], v[160:163], v[144:147], v[80:83]
  ds_read_b64_tr_b16 v[122:123], v54 offset:4096
  ds_read_b64_tr_b16 v[124:125], v55 offset:0
  v_mfma_f32_16x16x32_bf16 v[76:79], v[156:159], v[144:147], v[76:79]
  ds_read_b64_tr_b16 v[126:127], v55 offset:4096
  v_mfma_f32_16x16x32_bf16 v[88:91], v[156:159], v[148:151], v[88:91]
  v_mfma_f32_16x16x32_bf16 v[92:95], v[160:163], v[148:151], v[92:95]
  v_mfma_f32_16x16x32_bf16 v[96:99], v[164:167], v[148:151], v[96:99]
  v_mfma_f32_16x16x32_bf16 v[108:111], v[164:167], v[152:155], v[108:111]
  v_mfma_f32_16x16x32_bf16 v[104:107], v[160:163], v[152:155], v[104:107]
  v_mfma_f32_16x16x32_bf16 v[100:103], v[156:159], v[152:155], v[100:103]
  s_waitcnt lgkmcnt(6)
  v_mfma_f32_16x16x32_bf16 v[64:67], v[128:131], v[112:115], v[64:67]
  ds_read_b128 v[156:159], v57 offset:1024
  ds_read_b64_tr_b16 v[140:141], v52 offset:8192
  v_mfma_f32_16x16x32_bf16 v[68:71], v[132:135], v[112:115], v[68:71]
  ds_read_b64_tr_b16 v[142:143], v52 offset:12288
  ds_read_b128 v[160:163], v57 offset:3072
  v_mfma_f32_16x16x32_bf16 v[72:75], v[136:139], v[112:115], v[72:75]
  s_waitcnt lgkmcnt(8)
  ds_read_b128 v[164:167], v57 offset:5120
  v_mfma_f32_16x16x32_bf16 v[84:87], v[136:139], v[116:119], v[84:87]
  ds_read_b64_tr_b16 v[144:145], v53 offset:8192
  ds_read_b64_tr_b16 v[146:147], v53 offset:12288
  v_mfma_f32_16x16x32_bf16 v[80:83], v[132:135], v[116:119], v[80:83]
  ds_read_b64_tr_b16 v[148:149], v54 offset:8192
  ds_read_b64_tr_b16 v[150:151], v54 offset:12288
  v_mfma_f32_16x16x32_bf16 v[76:79], v[128:131], v[116:119], v[76:79]
  s_waitcnt lgkmcnt(9)
  ds_read_b64_tr_b16 v[152:153], v55 offset:8192
  v_mfma_f32_16x16x32_bf16 v[88:91], v[128:131], v[120:123], v[88:91]
  ds_read_b64_tr_b16 v[154:155], v55 offset:12288
  v_mfma_f32_16x16x32_bf16 v[92:95], v[132:135], v[120:123], v[92:95]
  v_mfma_f32_16x16x32_bf16 v[96:99], v[136:139], v[120:123], v[96:99]
  v_mfma_f32_16x16x32_bf16 v[108:111], v[136:139], v[124:127], v[108:111]
  v_mfma_f32_16x16x32_bf16 v[104:107], v[132:135], v[124:127], v[104:107]
  v_mfma_f32_16x16x32_bf16 v[100:103], v[128:131], v[124:127], v[100:103]
  s_waitcnt lgkmcnt(0)
  buffer_load_dwordx2 v[10:11], v39, s[32:35], s56 offen offset:0
  buffer_load_dwordx2 v[12:13], v39, s[32:35], s56 offen offset:32
  buffer_load_dwordx2 v[14:15], v39, s[32:35], s56 offen offset:64
  buffer_load_ushort v22, v9, s[28:31], s22 offen offset:0
  buffer_load_dwordx2 v[16:17], v39, s[32:35], s57 offen offset:0
  buffer_load_dwordx2 v[18:19], v39, s[32:35], s57 offen offset:32
  buffer_load_dwordx2 v[20:21], v39, s[32:35], s57 offen offset:64
  buffer_load_ushort v23, v9, s[28:31], s22 offen offset:32
  s_barrier
  v_mfma_f32_16x16x32_bf16 v[64:67], v[156:159], v[140:143], v[64:67]
  ds_read_b128 v[128:131], v57 offset:28672
  ds_read_b64_tr_b16 v[112:113], v52 offset:28672
  v_mfma_f32_16x16x32_bf16 v[68:71], v[160:163], v[140:143], v[68:71]
  ds_read_b64_tr_b16 v[114:115], v52 offset:32768
  ds_read_b128 v[132:135], v57 offset:30720
  v_mfma_f32_16x16x32_bf16 v[72:75], v[164:167], v[140:143], v[72:75]
  ds_read_b128 v[136:139], v57 offset:32768
  ds_read_b64_tr_b16 v[116:117], v53 offset:28672
  v_mfma_f32_16x16x32_bf16 v[84:87], v[164:167], v[144:147], v[84:87]
  ds_read_b64_tr_b16 v[118:119], v53 offset:32768
  ds_read_b64_tr_b16 v[120:121], v54 offset:28672
  v_mfma_f32_16x16x32_bf16 v[80:83], v[160:163], v[144:147], v[80:83]
  ds_read_b64_tr_b16 v[122:123], v54 offset:32768
  ds_read_b64_tr_b16 v[124:125], v55 offset:28672
  v_mfma_f32_16x16x32_bf16 v[76:79], v[156:159], v[144:147], v[76:79]
  ds_read_b64_tr_b16 v[126:127], v55 offset:32768
  v_mfma_f32_16x16x32_bf16 v[88:91], v[156:159], v[148:151], v[88:91]
  v_mfma_f32_16x16x32_bf16 v[92:95], v[160:163], v[148:151], v[92:95]
  v_mfma_f32_16x16x32_bf16 v[96:99], v[164:167], v[148:151], v[96:99]
  v_mfma_f32_16x16x32_bf16 v[108:111], v[164:167], v[152:155], v[108:111]
  v_mfma_f32_16x16x32_bf16 v[104:107], v[160:163], v[152:155], v[104:107]
  v_mfma_f32_16x16x32_bf16 v[100:103], v[156:159], v[152:155], v[100:103]
  s_waitcnt lgkmcnt(6)
  v_mfma_f32_16x16x32_bf16 v[64:67], v[128:131], v[112:115], v[64:67]
  ds_read_b128 v[156:159], v57 offset:29696
  ds_read_b64_tr_b16 v[140:141], v52 offset:36864
  v_mfma_f32_16x16x32_bf16 v[68:71], v[132:135], v[112:115], v[68:71]
  ds_read_b64_tr_b16 v[142:143], v52 offset:40960
  ds_read_b128 v[160:163], v57 offset:31744
  v_mfma_f32_16x16x32_bf16 v[72:75], v[136:139], v[112:115], v[72:75]
  s_waitcnt lgkmcnt(8)
  ds_read_b128 v[164:167], v57 offset:33792
  v_mfma_f32_16x16x32_bf16 v[84:87], v[136:139], v[116:119], v[84:87]
  ds_read_b64_tr_b16 v[144:145], v53 offset:36864
  ds_read_b64_tr_b16 v[146:147], v53 offset:40960
  v_mfma_f32_16x16x32_bf16 v[80:83], v[132:135], v[116:119], v[80:83]
  ds_read_b64_tr_b16 v[148:149], v54 offset:36864
  ds_read_b64_tr_b16 v[150:151], v54 offset:40960
  v_mfma_f32_16x16x32_bf16 v[76:79], v[128:131], v[116:119], v[76:79]
  s_waitcnt lgkmcnt(9)
  ds_read_b64_tr_b16 v[152:153], v55 offset:36864
  v_mfma_f32_16x16x32_bf16 v[88:91], v[128:131], v[120:123], v[88:91]
  ds_read_b64_tr_b16 v[154:155], v55 offset:40960
  v_mfma_f32_16x16x32_bf16 v[92:95], v[132:135], v[120:123], v[92:95]
  v_mfma_f32_16x16x32_bf16 v[96:99], v[136:139], v[120:123], v[96:99]
  v_mfma_f32_16x16x32_bf16 v[108:111], v[136:139], v[124:127], v[108:111]
  v_mfma_f32_16x16x32_bf16 v[104:107], v[132:135], v[124:127], v[104:107]
  v_mfma_f32_16x16x32_bf16 v[100:103], v[128:131], v[124:127], v[100:103]
  s_waitcnt lgkmcnt(0)
  v_mfma_f32_16x16x32_bf16 v[64:67], v[156:159], v[140:143], v[64:67]
  v_mfma_f32_16x16x32_bf16 v[68:71], v[160:163], v[140:143], v[68:71]
  v_mfma_f32_16x16x32_bf16 v[72:75], v[164:167], v[140:143], v[72:75]
  v_mfma_f32_16x16x32_bf16 v[84:87], v[164:167], v[144:147], v[84:87]
  v_mfma_f32_16x16x32_bf16 v[80:83], v[160:163], v[144:147], v[80:83]
  v_mfma_f32_16x16x32_bf16 v[76:79], v[156:159], v[144:147], v[76:79]
  v_mfma_f32_16x16x32_bf16 v[88:91], v[156:159], v[148:151], v[88:91]
  v_mfma_f32_16x16x32_bf16 v[92:95], v[160:163], v[148:151], v[92:95]
  v_mfma_f32_16x16x32_bf16 v[96:99], v[164:167], v[148:151], v[96:99]
  v_mfma_f32_16x16x32_bf16 v[108:111], v[164:167], v[152:155], v[108:111]
  v_mfma_f32_16x16x32_bf16 v[104:107], v[160:163], v[152:155], v[104:107]
  v_mfma_f32_16x16x32_bf16 v[100:103], v[156:159], v[152:155], v[100:103]
  s_mov_b32 s44, s54
  s_mov_b32 s45, s55
  s_mov_b32 s46, 0x240000
  s_mov_b32 s47, 0x20000
  v_mov_b32 v58, v39
  v_mov_b32 v59, v31
  v_cvt_pk_bf16_f32 v172, v88, v89
  v_cvt_pk_bf16_f32 v173, v90, v91
  v_cvt_pk_bf16_f32 v174, v92, v93
  v_mov_b32 v175, s101
  buffer_store_dwordx4 v[172:175], v7, s[8:11], s59 offen sc1
  s_add_u32 s59, s59, 1024
  v_cvt_pk_bf16_f32 v176, v94, v95
  v_cvt_pk_bf16_f32 v177, v96, v97
  v_cvt_pk_bf16_f32 v178, v98, v99
  v_mov_b32 v179, s101
  buffer_store_dwordx4 v[176:179], v7, s[8:11], s59 offen sc1
  s_add_u32 s59, s59, 1024
  v_cvt_pk_bf16_f32 v180, v100, v101
  v_cvt_pk_bf16_f32 v181, v102, v103
  v_cvt_pk_bf16_f32 v182, v104, v105
  v_mov_b32 v183, s101
  buffer_store_dwordx4 v[180:183], v7, s[8:11], s59 offen sc1
  s_add_u32 s59, s59, 1024
  v_cvt_pk_bf16_f32 v184, v106, v107
  v_cvt_pk_bf16_f32 v185, v108, v109
  v_cvt_pk_bf16_f32 v186, v110, v111
  v_mov_b32 v187, s101
  buffer_store_dwordx4 v[184:187], v7, s[8:11], s59 offen sc1
  s_add_u32 s59, s59, 1024
  s_barrier
  ds_read_b64_tr_b16 v[112:113], v59 offset:0
  ds_read_b64_tr_b16 v[114:115], v59 offset:2048
  ds_read_b64_tr_b16 v[116:117], v59 offset:4096
  ds_read_b64_tr_b16 v[118:119], v59 offset:32
  ds_read_b64_tr_b16 v[120:121], v59 offset:2080
  ds_read_b64_tr_b16 v[122:123], v59 offset:4128
  s_waitcnt vmcnt(4)
  v_lshlrev_b32 v22, 16, v22
  v_lshlrev_b32 v24, 16, v23
  s_waitcnt lgkmcnt(0)
  v_lshlrev_b32 v26, 16, v10
  v_and_b32 v27, 0xffff0000, v10
  v_lshlrev_b32 v28, 16, v112
  v_and_b32 v29, 0xffff0000, v112
  v_pk_add_f32 v[26:27], v[26:27], v[28:29]
  v_pk_add_f32 v[64:65], v[64:65], v[22:23] op_sel_hi:[1,0]
  v_pk_add_f32 v[64:65], v[64:65], v[26:27]
  v_lshlrev_b32 v26, 16, v11
  v_and_b32 v27, 0xffff0000, v11
  v_lshlrev_b32 v28, 16, v113
  v_and_b32 v29, 0xffff0000, v113
  v_pk_add_f32 v[26:27], v[26:27], v[28:29]
  v_pk_add_f32 v[66:67], v[66:67], v[22:23] op_sel_hi:[1,0]
  v_pk_add_f32 v[66:67], v[66:67], v[26:27]
  v_lshlrev_b32 v26, 16, v12
  v_and_b32 v27, 0xffff0000, v12
  v_lshlrev_b32 v28, 16, v114
  v_and_b32 v29, 0xffff0000, v114
  v_pk_add_f32 v[26:27], v[26:27], v[28:29]
  v_pk_add_f32 v[68:69], v[68:69], v[22:23] op_sel_hi:[1,0]
  v_pk_add_f32 v[68:69], v[68:69], v[26:27]
  v_lshlrev_b32 v26, 16, v13
  v_and_b32 v27, 0xffff0000, v13
  v_lshlrev_b32 v28, 16, v115
  v_and_b32 v29, 0xffff0000, v115
  v_pk_add_f32 v[26:27], v[26:27], v[28:29]
  v_pk_add_f32 v[70:71], v[70:71], v[22:23] op_sel_hi:[1,0]
  v_pk_add_f32 v[70:71], v[70:71], v[26:27]
  v_lshlrev_b32 v26, 16, v14
  v_and_b32 v27, 0xffff0000, v14
  v_lshlrev_b32 v28, 16, v116
  v_and_b32 v29, 0xffff0000, v116
  v_pk_add_f32 v[26:27], v[26:27], v[28:29]
  v_pk_add_f32 v[72:73], v[72:73], v[22:23] op_sel_hi:[1,0]
  v_pk_add_f32 v[72:73], v[72:73], v[26:27]
  v_lshlrev_b32 v26, 16, v15
  v_and_b32 v27, 0xffff0000, v15
  v_lshlrev_b32 v28, 16, v117
  v_and_b32 v29, 0xffff0000, v117
  v_pk_add_f32 v[26:27], v[26:27], v[28:29]
  v_pk_add_f32 v[74:75], v[74:75], v[22:23] op_sel_hi:[1,0]
  v_pk_add_f32 v[74:75], v[74:75], v[26:27]
  v_lshlrev_b32 v26, 16, v16
  v_and_b32 v27, 0xffff0000, v16
  v_lshlrev_b32 v28, 16, v118
  v_and_b32 v29, 0xffff0000, v118
  v_pk_add_f32 v[26:27], v[26:27], v[28:29]
  v_pk_add_f32 v[76:77], v[76:77], v[24:25] op_sel_hi:[1,0]
  v_pk_add_f32 v[76:77], v[76:77], v[26:27]
  v_lshlrev_b32 v26, 16, v17
  v_and_b32 v27, 0xffff0000, v17
  v_lshlrev_b32 v28, 16, v119
  v_and_b32 v29, 0xffff0000, v119
  v_pk_add_f32 v[26:27], v[26:27], v[28:29]
  v_pk_add_f32 v[78:79], v[78:79], v[24:25] op_sel_hi:[1,0]
  v_pk_add_f32 v[78:79], v[78:79], v[26:27]
  v_lshlrev_b32 v26, 16, v18
  v_and_b32 v27, 0xffff0000, v18
  v_lshlrev_b32 v28, 16, v120
  v_and_b32 v29, 0xffff0000, v120
  v_pk_add_f32 v[26:27], v[26:27], v[28:29]
  v_pk_add_f32 v[80:81], v[80:81], v[24:25] op_sel_hi:[1,0]
  v_pk_add_f32 v[80:81], v[80:81], v[26:27]
  v_lshlrev_b32 v26, 16, v19
  v_and_b32 v27, 0xffff0000, v19
  v_lshlrev_b32 v28, 16, v121
  v_and_b32 v29, 0xffff0000, v121
  v_pk_add_f32 v[26:27], v[26:27], v[28:29]
  v_pk_add_f32 v[82:83], v[82:83], v[24:25] op_sel_hi:[1,0]
  v_pk_add_f32 v[82:83], v[82:83], v[26:27]
  v_lshlrev_b32 v26, 16, v20
  v_and_b32 v27, 0xffff0000, v20
  v_lshlrev_b32 v28, 16, v122
  v_and_b32 v29, 0xffff0000, v122
  v_pk_add_f32 v[26:27], v[26:27], v[28:29]
  v_pk_add_f32 v[84:85], v[84:85], v[24:25] op_sel_hi:[1,0]
  v_pk_add_f32 v[84:85], v[84:85], v[26:27]
  v_lshlrev_b32 v26, 16, v21
  v_and_b32 v27, 0xffff0000, v21
  v_lshlrev_b32 v28, 16, v123
  v_and_b32 v29, 0xffff0000, v123
  v_pk_add_f32 v[26:27], v[26:27], v[28:29]
  v_pk_add_f32 v[86:87], v[86:87], v[24:25] op_sel_hi:[1,0]
  v_pk_add_f32 v[86:87], v[86:87], v[26:27]
  s_waitcnt vmcnt(0)
  s_mov_b32 s61, 0x100000
  s_add_u32 s62, s60, 4096
L_xch_poll:
  buffer_load_dwordx4 v[204:207], v7, s[8:11], s60 offen offset:0 sc1
  buffer_load_dwordx4 v[208:211], v7, s[8:11], s60 offen offset:1024 sc1
  buffer_load_dwordx4 v[212:215], v7, s[8:11], s60 offen offset:2048 sc1
  buffer_load_dwordx4 v[216:219], v7, s[8:11], s60 offen offset:3072 sc1
  s_sub_u32 s61, s61, 1
  s_cbranch_scc1 L_xch_go
  s_waitcnt vmcnt(0)
  v_xor_b32 v4, s101, v207
  v_xor_b32 v5, s101, v211
  v_or_b32 v4, v4, v5
  v_xor_b32 v5, s101, v215
  v_or_b32 v4, v4, v5
  v_xor_b32 v5, s101, v219
  v_or_b32 v4, v4, v5
  v_cmp_ne_u32 vcc, 0, v4
  s_nop 0
  s_cmp_eq_u64 vcc, 0
  s_cbranch_scc1 L_xch_go
  s_branch L_xch_poll
L_xch_go:
  v_lshlrev_b32 v26, 16, v204
  v_and_b32 v27, 0xffff0000, v204
  v_lshlrev_b32 v28, 16, v205
  v_and_b32 v29, 0xffff0000, v205
  v_pk_add_f32 v[64:65], v[64:65], v[26:27]
  v_pk_add_f32 v[66:67], v[66:67], v[28:29]
  v_cvt_pk_bf16_f32 v10, v64, v65
  v_cvt_pk_bf16_f32 v11, v66, v67
  buffer_store_dwordx2 v[10:11], v58, s[44:47], s56 offen offset:0
  v_lshlrev_b32 v26, 16, v206
  v_and_b32 v27, 0xffff0000, v206
  v_lshlrev_b32 v28, 16, v208
  v_and_b32 v29, 0xffff0000, v208
  v_pk_add_f32 v[68:69], v[68:69], v[26:27]
  v_pk_add_f32 v[70:71], v[70:71], v[28:29]
  v_cvt_pk_bf16_f32 v12, v68, v69
  v_cvt_pk_bf16_f32 v13, v70, v71
  buffer_store_dwordx2 v[12:13], v58, s[44:47], s56 offen offset:32
  v_lshlrev_b32 v26, 16, v209
  v_and_b32 v27, 0xffff0000, v209
  v_lshlrev_b32 v28, 16, v210
  v_and_b32 v29, 0xffff0000, v210
  v_pk_add_f32 v[72:73], v[72:73], v[26:27]
  v_pk_add_f32 v[74:75], v[74:75], v[28:29]
  v_cvt_pk_bf16_f32 v14, v72, v73
  v_cvt_pk_bf16_f32 v15, v74, v75
  buffer_store_dwordx2 v[14:15], v58, s[44:47], s56 offen offset:64
  v_lshlrev_b32 v26, 16, v212
  v_and_b32 v27, 0xffff0000, v212
  v_lshlrev_b32 v28, 16, v213
  v_and_b32 v29, 0xffff0000, v213
  v_pk_add_f32 v[76:77], v[76:77], v[26:27]
  v_pk_add_f32 v[78:79], v[78:79], v[28:29]
  v_cvt_pk_bf16_f32 v16, v76, v77
  v_cvt_pk_bf16_f32 v17, v78, v79
  buffer_store_dwordx2 v[16:17], v58, s[44:47], s57 offen offset:0
  v_lshlrev_b32 v26, 16, v214
  v_and_b32 v27, 0xffff0000, v214
  v_lshlrev_b32 v28, 16, v216
  v_and_b32 v29, 0xffff0000, v216
  v_pk_add_f32 v[80:81], v[80:81], v[26:27]
  v_pk_add_f32 v[82:83], v[82:83], v[28:29]
  v_cvt_pk_bf16_f32 v18, v80, v81
  v_cvt_pk_bf16_f32 v19, v82, v83
  buffer_store_dwordx2 v[18:19], v58, s[44:47], s57 offen offset:32
  v_lshlrev_b32 v26, 16, v217
  v_and_b32 v27, 0xffff0000, v217
  v_lshlrev_b32 v28, 16, v218
  v_and_b32 v29, 0xffff0000, v218
  v_pk_add_f32 v[84:85], v[84:85], v[26:27]
  v_pk_add_f32 v[86:87], v[86:87], v[28:29]
  v_cvt_pk_bf16_f32 v20, v84, v85
  v_cvt_pk_bf16_f32 v21, v86, v87
  buffer_store_dwordx2 v[20:21], v58, s[44:47], s57 offen offset:64
  s_endpgm
L_m_conv1:
  s_waitcnt vmcnt(0)
  v_mov_b32 v58, 158728
  v_mov_b32 v59, 1
  v_mov_b32 v61, 0
  s_mov_b64 exec, 1
  ds_add_rtn_u32 v60, v58, v59
  s_waitcnt lgkmcnt(0)
  v_readfirstlane_b32 s23, v60
  s_nop 0
  s_cmp_lg_u32 s23, 3
  s_cbranch_scc1 L_gd_notlast
  v_mov_b32 v59, s101
  buffer_store_dword v59, v61, s[40:43], s24 offen sc1
L_gd_notlast:
  s_mov_b64 exec, -1
  s_mov_b32 s30, 1
  s_sub_u32 s31, s2, 72
  s_lshl_b32 s31, s31, 2
  s_add_u32 s31, s31, s20
  s_mov_b32 s24, s80
  s_mov_b32 s25, s81
  s_mov_b32 s26, 0x24000
  s_mov_b32 s27, 0x20000
  s_mov_b32 s44, s82
  s_mov_b32 s45, s83
  s_mov_b32 s46, 0x24000
  s_mov_b32 s47, 0x20000
  s_mov_b32 s48, s84
  s_mov_b32 s49, s85
  s_mov_b32 s50, 0x24000
  s_mov_b32 s51, 0x20000
  s_mov_b32 s52, s86
  s_mov_b32 s53, s87
  s_mov_b32 s54, 0x24000
  s_mov_b32 s55, 0x20000
  s_mov_b32 s56, s88
  s_mov_b32 s57, s89
  s_mov_b32 s58, 0x480
  s_mov_b32 s59, 0x20000
  s_mov_b32 s60, s90
  s_mov_b32 s61, s91
  s_mov_b32 s62, 0x480
  s_mov_b32 s63, 0x20000
  s_lshl_b32 s37, s31, 1
  s_lshl_b32 s36, s31, 8
  v_lshlrev_b32 v254, 2, v1
  v_lshlrev_b32 v255, 1, v1
  buffer_load_ushort v248, v255, s[56:59], s37 offen
  buffer_load_ushort v249, v255, s[60:63], s37 offen
  buffer_load_dword v224, v254, s[24:27], s36 offen offset:0
  buffer_load_dword v225, v254, s[44:47], s36 offen offset:0
  buffer_load_dword v226, v254, s[48:51], s36 offen offset:0
  buffer_load_dword v227, v254, s[52:55], s36 offen offset:0
  buffer_load_dword v228, v254, s[24:27], s36 offen offset:256
  buffer_load_dword v229, v254, s[44:47], s36 offen offset:256
  buffer_load_dword v230, v254, s[48:51], s36 offen offset:256
  buffer_load_dword v231, v254, s[52:55], s36 offen offset:256
  buffer_load_dword v232, v254, s[24:27], s36 offen offset:512
  buffer_load_dword v233, v254, s[44:47], s36 offen offset:512
  buffer_load_dword v234, v254, s[48:51], s36 offen offset:512
  buffer_load_dword v235, v254, s[52:55], s36 offen offset:512
  s_branch L_m_conv2
L_m_conv:
  s_sub_u32 s31, s2, 216
  s_lshl_b32 s31, s31, 2
  s_add_u32 s31, s31, s20
  s_mul_i32 s31, s31, 3
  s_mov_b32 s28, s24
  s_mov_b32 s24, s80
  s_mov_b32 s25, s81
  s_mov_b32 s26, 0x24000
  s_mov_b32 s27, 0x20000
  s_mov_b32 s44, s82
  s_mov_b32 s45, s83
  s_mov_b32 s46, 0x24000
  s_mov_b32 s47, 0x20000
  s_mov_b32 s48, s84
  s_mov_b32 s49, s85
  s_mov_b32 s50, 0x24000
  s_mov_b32 s51, 0x20000
  s_mov_b32 s52, s86
  s_mov_b32 s53, s87
  s_mov_b32 s54, 0x24000
  s_mov_b32 s55, 0x20000
  s_mov_b32 s56, s88
  s_mov_b32 s57, s89
  s_mov_b32 s58, 0x480
  s_mov_b32 s59, 0x20000
  s_mov_b32 s60, s90
  s_mov_b32 s61, s91
  s_mov_b32 s62, 0x480
  s_mov_b32 s63, 0x20000
  s_lshl_b32 s37, s31, 1
  s_lshl_b32 s36, s31, 8
  v_lshlrev_b32 v254, 2, v1
  v_lshlrev_b32 v255, 1, v1
  buffer_load_ushort v248, v255, s[56:59], s37 offen
  buffer_load_ushort v249, v255, s[60:63], s37 offen
  buffer_load_dword v224, v254, s[24:27], s36 offen offset:0
  buffer_load_dword v225, v254, s[44:47], s36 offen offset:0
  buffer_load_dword v226, v254, s[48:51], s36 offen offset:0
  buffer_load_dword v227, v254, s[52:55], s36 offen offset:0
  buffer_load_dword v228, v254, s[24:27], s36 offen offset:256
  buffer_load_dword v229, v254, s[44:47], s36 offen offset:256
  buffer_load_dword v230, v254, s[48:51], s36 offen offset:256
  buffer_load_dword v231, v254, s[52:55], s36 offen offset:256
  buffer_load_dword v232, v254, s[24:27], s36 offen offset:512
  buffer_load_dword v233, v254, s[44:47], s36 offen offset:512
  buffer_load_dword v234, v254, s[48:51], s36 offen offset:512
  buffer_load_dword v235, v254, s[52:55], s36 offen offset:512
  s_waitcnt vmcnt(14)
  v_mov_b32 v58, 158732
  v_mov_b32 v59, 1
  v_mov_b32 v61, 0
  s_mov_b64 exec, 1
  ds_add_rtn_u32 v60, v58, v59
  s_waitcnt lgkmcnt(0)
  v_readfirstlane_b32 s23, v60
  s_nop 0
  s_cmp_lg_u32 s23, 3
  s_cbranch_scc1 L_xnd2_notlast
  v_mov_b32 v59, s101
  buffer_store_dword v59, v61, s[40:43], s28 offen sc1
L_xnd2_notlast:
  s_mov_b64 exec, -1
  s_mov_b32 s30, 3
L_m_conv2:
  s_mul_i32 s29, s31, 683
  s_lshr_b32 s29, s29, 16
  s_add_u32 s8, s4, 0x0
  s_addc_u32 s9, s5, 0
  s_mov_b32 s10, 0x40000
  s_mov_b32 s11, 0x20000
  s_add_u32 s16, s4, 0x280000
  s_addc_u32 s17, s5, 0
  s_mov_b32 s18, 0x240000
  s_mov_b32 s19, 0x20000
  s_add_u32 s24, s4, 0x9d0000
  s_addc_u32 s25, s5, 0
  s_mov_b32 s26, 0x240000
  s_mov_b32 s27, 0x20000
  s_mul_i32 s34, s20, 29328
  s_mov_b32 s48, 0x3fb8aa3b
  v_lshl_add_u32 v27, v1, 2, s34
  v_mov_b32 v4, 0
  v_mov_b32 v5, 0
  v_lshl_add_u32 v6, v1, 3, s34
  ds_write_b64 v6, v[4:5] offset:15504
  ds_write_b64 v6, v[4:5] offset:16016
  ds_write_b64 v6, v[4:5] offset:16528
  v_and_b32 v8, 15, v1
  v_lshrrev_b32 v9, 4, v1
  v_add_u32 v10, 1, v8
  v_lshrrev_b32 v10, 1, v10
  v_lshlrev_b32 v11, 2, v9
  v_sub_u32 v10, v11, v10
  v_add_u32 v10, 792, v10
  v_and_b32 v11, 1, v8
  v_xor_b32 v11, 1, v11
  v_mul_u32_u24 v11, 1039, v11
  v_add_u32 v10, v10, v11
  v_lshl_add_u32 v20, v10, 2, s34
  v_subrev_u32 v21, 1024, v20
  v_subrev_u32 v22, 2048, v20
  v_subrev_u32 v23, 3072, v20
  v_lshl_add_u32 v11, v8, 1, v9
  s_add_u32 s36, s34, 15504
  v_add_u32 v12, 30, v11
  v_lshrrev_b32 v13, 4, v12
  v_mul_u32_u24 v13, 768, v13
  v_and_b32 v12, 15, v12
  v_lshl_add_u32 v12, v12, 4, v13
  v_add_u32 v50, s36, v12
  v_add_u32 v12, 26, v11
  v_lshrrev_b32 v13, 4, v12
  v_mul_u32_u24 v13, 768, v13
  v_and_b32 v12, 15, v12
  v_lshl_add_u32 v12, v12, 4, v13
  v_add_u32 v51, s36, v12
  v_add_u32 v12, 22, v11
  v_lshrrev_b32 v13, 4, v12
  v_mul_u32_u24 v13, 768, v13
  v_and_b32 v12, 15, v12
  v_lshl_add_u32 v12, v12, 4, v13
  v_add_u32 v52, s36, v12
  v_add_u32 v12, 18, v11
  v_lshrrev_b32 v13, 4, v12
  v_mul_u32_u24 v13, 768, v13
  v_and_b32 v12, 15, v12
  v_lshl_add_u32 v12, v12, 4, v13
  v_add_u32 v53, s36, v12
  v_add_u32 v12, 14, v11
  v_lshrrev_b32 v13, 4, v12
  v_mul_u32_u24 v13, 768, v13
  v_and_b32 v12, 15, v12
  v_lshl_add_u32 v12, v12, 4, v13
  v_add_u32 v54, s36, v12
  v_add_u32 v12, 10, v11
  v_lshrrev_b32 v13, 4, v12
  v_mul_u32_u24 v13, 768, v13
  v_and_b32 v12, 15, v12
  v_lshl_add_u32 v12, v12, 4, v13
  v_add_u32 v55, s36, v12
  v_add_u32 v12, 6, v11
  v_lshrrev_b32 v13, 4, v12
  v_mul_u32_u24 v13, 768, v13
  v_and_b32 v12, 15, v12
  v_lshl_add_u32 v12, v12, 4, v13
  v_add_u32 v56, s36, v12
  v_add_u32 v12, 2, v11
  v_lshrrev_b32 v13, 4, v12
  v_mul_u32_u24 v13, 768, v13
  v_and_b32 v12, 15, v12
  v_lshl_add_u32 v12, v12, 4, v13
  v_add_u32 v57, s36, v12
  v_lshlrev_b32 v10, 5, v8
  v_lshl_add_u32 v25, v9, 3, v10
  v_mul_u32_u24 v10, 272, v8
  v_lshl_add_u32 v10, v9, 4, v10
  v_add_u32 v26, s34, v10
  v_lshlrev_b32 v10, 3, v9
  v_sub_u32 v10, v8, v10
  v_add_u32 v10, 16, v10
  v_mov_b32 v11, 0xffff
  v_mov_b32 v12, 0xffff0000
  v_cmp_eq_u32 vcc, 0, v10
  s_nop 1
  v_cndmask_b32 v13, 0, v11, vcc
  v_cmp_eq_u32 vcc, 1, v10
  s_nop 1
  v_cndmask_b32 v28, v13, v12, vcc
  v_cmp_eq_u32 vcc, 2, v10
  s_nop 1
  v_cndmask_b32 v13, 0, v11, vcc
  v_cmp_eq_u32 vcc, 3, v10
  s_nop 1
  v_cndmask_b32 v29, v13, v12, vcc
  v_cmp_eq_u32 vcc, 4, v10
  s_nop 1
  v_cndmask_b32 v13, 0, v11, vcc
  v_cmp_eq_u32 vcc, 5, v10
  s_nop 1
  v_cndmask_b32 v30, v13, v12, vcc
  v_cmp_eq_u32 vcc, 6, v10
  s_nop 1
  v_cndmask_b32 v13, 0, v11, vcc
  v_cmp_eq_u32 vcc, 7, v10
  s_nop 1
  v_cndmask_b32 v31, v13, v12, vcc
  s_add_u32 s36, s34, 64
  v_lshlrev_b32 v10, 4, v8
  v_lshl_add_u32 v11, v9, 10, v10
  v_sub_u32 v11, 1272, v11
  v_add_u32 v44, s36, v11
  v_lshl_add_u32 v11, v9, 9, v10
  v_sub_u32 v11, 3828, v11
  v_add_u32 v45, s36, v11
  v_lshl_add_u32 v11, v9, 8, v10
  v_sub_u32 v11, 3570, v11
  v_add_u32 v46, s36, v11
  v_add_u32 v47, 2, v46
  v_lshrrev_b32 v11, 1, v9
  v_lshl_add_u32 v11, v11, 8, v10
  v_and_b32 v12, 1, v9
  v_lshl_add_u32 v11, v12, 3, v11
  v_sub_u32 v11, 4088, v11
  v_add_u32 v48, s36, v11
  v_and_b32 v11, 7, v1
  v_lshl_add_u32 v49, v11, 3, s34
  s_mov_b32 s38, 0
  s_lshr_b32 s35, s30, 1
  s_cmp_eq_u32 s35, 1
  s_cbranch_scc1 L_cv_late
  v_mul_u32_u24 v61, 256, v1
  s_mov_b32 s61, 0x100000
L_cvln1_poll:
  s_mov_b32 s62, 196608
  buffer_load_dwordx4 v[180:183], v61, s[8:11], s62 offen sc1
  s_sub_u32 s61, s61, 1
  s_cbranch_scc1 L_cvln1_go
  s_waitcnt vmcnt(0)
  v_xor_b32 v180, s101, v180
  v_xor_b32 v181, s101, v181
  v_xor_b32 v182, s101, v182
  v_xor_b32 v183, s101, v183
  v_or3_b32 v180, v180, v181, v182
  v_or_b32 v180, v180, v183
  v_cmp_ne_u32 vcc, 0, v180
  s_nop 0
  s_cmp_eq_u64 vcc, 0
  s_cbranch_scc1 L_cvln1_go
  s_sleep 4
  s_branch L_cvln1_poll
L_cvln1_go:
  v_lshrrev_b32 v4, 4, v1
  v_add_u32 v4, s31, v4
  v_lshrrev_b32 v5, 4, v4
  v_and_b32 v4, 15, v4
  v_lshlrev_b32 v4, 4, v4
  v_lshl_add_u32 v4, v5, 16, v4
  v_and_b32 v5, 15, v1
  v_lshl_add_u32 v2, v5, 8, v4
  s_lshl_b32 s32, s30, 4
  s_lshl_b64 s[32:33], 1, s32
  s_sub_u32 s32, s32, 1
  s_subb_u32 s33, s33, 0
  s_mov_b64 exec, s[32:33]
  s_add_u32 m0, s34, 17040
  s_mov_b32 s33, 0
  buffer_load_dwordx4 v2, s[16:19], s33 offen lds
  s_add_u32 m0, s34, 17808
  s_mov_b32 s33, 4096
  buffer_load_dwordx4 v2, s[16:19], s33 offen lds
  s_add_u32 m0, s34, 18576
  s_mov_b32 s33, 8192
  buffer_load_dwordx4 v2, s[16:19], s33 offen lds
  s_add_u32 m0, s34, 19344
  s_mov_b32 s33, 12288
  buffer_load_dwordx4 v2, s[16:19], s33 offen lds
  s_add_u32 m0, s34, 20112
  s_mov_b32 s33, 16384
  buffer_load_dwordx4 v2, s[16:19], s33 offen lds
  s_add_u32 m0, s34, 20880
  s_mov_b32 s33, 20480
  buffer_load_dwordx4 v2, s[16:19], s33 offen lds
  s_add_u32 m0, s34, 21648
  s_mov_b32 s33, 24576
  buffer_load_dwordx4 v2, s[16:19], s33 offen lds
  s_add_u32 m0, s34, 22416
  s_mov_b32 s33, 28672
  buffer_load_dwordx4 v2, s[16:19], s33 offen lds
  s_add_u32 m0, s34, 23184
  s_mov_b32 s33, 32768
  buffer_load_dwordx4 v2, s[16:19], s33 offen lds
  s_add_u32 m0, s34, 23952
  s_mov_b32 s33, 36864
  buffer_load_dwordx4 v2, s[16:19], s33 offen lds
  s_add_u32 m0, s34, 24720
  s_mov_b32 s33, 40960
  buffer_load_dwordx4 v2, s[16:19], s33 offen lds
  s_add_u32 m0, s34, 25488
  s_mov_b32 s33, 45056
  buffer_load_dwordx4 v2, s[16:19], s33 offen lds
  s_add_u32 m0, s34, 26256
  s_mov_b32 s33, 49152
  buffer_load_dwordx4 v2, s[16:19], s33 offen lds
  s_add_u32 m0, s34, 27024
  s_mov_b32 s33, 53248
  buffer_load_dwordx4 v2, s[16:19], s33 offen lds
  s_add_u32 m0, s34, 27792
  s_mov_b32 s33, 57344
  buffer_load_dwordx4 v2, s[16:19], s33 offen lds
  s_add_u32 m0, s34, 28560
  s_mov_b32 s33, 61440
  buffer_load_dwordx4 v2, s[16:19], s33 offen lds
  s_mov_b64 exec, -1
  s_branch L_cv_round
L_cv_late:
  s_waitcnt vmcnt(0)
L_cv_round:
  v_readlane_b32 s40, v248, s38
  s_nop 0
  s_lshl_b32 s40, s40, 16
  v_mov_b32 v14, s48
  v_mul_f32 v14, s40, v14
  v_exp_f32 v14, v14
  v_mov_b32 v100, 0
  v_mov_b32 v101, 0
  v_mov_b32 v102, 0
  v_mov_b32 v103, 0
  v_mov_b32 v104, 0
  v_mov_b32 v105, 0
  v_mov_b32 v106, 0
  v_mov_b32 v107, 0
  v_mov_b32 v108, 0
  v_mov_b32 v109, 0
  v_mov_b32 v110, 0
  v_mov_b32 v111, 0
  v_cvt_pk_bf16_f32 v14, v14, v14
  v_lshlrev_b32 v14, 16, v14
  s_mov_b32 s41, 0
L_cv_half:
  v_lshlrev_b32 v10, 16, v224
  v_lshlrev_b32 v11, 16, v225
  v_lshlrev_b32 v12, 16, v226
  v_lshlrev_b32 v13, 16, v227
  v_mul_f32 v10, s48, v10
  v_exp_f32 v10, v10
  v_mul_f32 v11, v11, v14
  v_mul_f32 v12, v12, v14
  v_mul_f32 v13, v13, v14
  v_cvt_pk_bf16_f32 v10, v10, v10
  v_lshlrev_b32 v10, 16, v10
  v_mul_f32 v10, v10, v14
  v_mul_f32 v11, 0.15915494, v11
  v_mul_f32 v10, s48, v10
  v_add_f32 v86, v12, v12
  v_add_f32 v87, v13, v13
  v_mul_f32 v5, -1.0, v10
  v_mul_f32 v6, 1.0, v11
  v_exp_f32 v5, v5
  v_fract_f32 v6, v6
  v_cos_f32 v7, v6
  v_sin_f32 v8, v6
  v_mul_f32 v64, v5, v7
  v_mul_f32 v65, v5, v8
  v_mul_f32 v5, -8.0, v10
  v_mul_f32 v6, 8.0, v11
  v_exp_f32 v5, v5
  v_fract_f32 v6, v6
  v_cos_f32 v7, v6
  v_sin_f32 v8, v6
  v_mul_f32 v78, v5, v7
  v_mul_f32 v79, v5, v8
  v_mul_f32 v5, -128.0, v10
  v_mul_f32 v6, 128.0, v11
  v_exp_f32 v5, v5
  v_fract_f32 v6, v6
  v_cos_f32 v7, v6
  v_sin_f32 v8, v6
  v_mul_f32 v80, v5, v7
  v_mul_f32 v81, v5, v8
  v_pk_mul_f32 v[66:67], v[64:65], v[64:65] op_sel_hi:[0,1]
  v_pk_fma_f32 v[66:67], v[64:65], v[64:65], v[66:67] op_sel:[1,1,0] op_sel_hi:[1,0,1] neg_lo:[0,1,0]
  v_pk_mul_f32 v[68:69], v[66:67], v[64:65] op_sel_hi:[0,1]
  v_pk_fma_f32 v[68:69], v[66:67], v[64:65], v[68:69] op_sel:[1,1,0] op_sel_hi:[1,0,1] neg_lo:[0,1,0]
  v_pk_mul_f32 v[70:71], v[66:67], v[66:67] op_sel_hi:[0,1]
  v_pk_fma_f32 v[70:71], v[66:67], v[66:67], v[70:71] op_sel:[1,1,0] op_sel_hi:[1,0,1] neg_lo:[0,1,0]
  v_pk_mul_f32 v[72:73], v[70:71], v[64:65] op_sel_hi:[0,1]
  v_pk_fma_f32 v[72:73], v[70:71], v[64:65], v[72:73] op_sel:[1,1,0] op_sel_hi:[1,0,1] neg_lo:[0,1,0]
  v_pk_mul_f32 v[74:75], v[70:71], v[66:67] op_sel_hi:[0,1]
  v_pk_fma_f32 v[74:75], v[70:71], v[66:67], v[74:75] op_sel:[1,1,0] op_sel_hi:[1,0,1] neg_lo:[0,1,0]
  v_pk_mul_f32 v[76:77], v[70:71], v[68:69] op_sel_hi:[0,1]
  v_pk_fma_f32 v[76:77], v[70:71], v[68:69], v[76:77] op_sel:[1,1,0] op_sel_hi:[1,0,1] neg_lo:[0,1,0]
  v_mov_b32 v98, 0x3f80
  ds_write_b32 v27, v98 offset:11152
  v_cvt_pk_bf16_f32 v94, v78, v79
  ds_write_b32 v27, v94 offset:11424
  v_pk_mul_f32 v[88:89], v[86:87], v[80:81] op_sel_hi:[0,1]
  v_pk_fma_f32 v[88:89], v[86:87], v[80:81], v[88:89] op_sel:[1,1,0] op_sel_hi:[1,0,1] neg_lo:[0,1,0]
  v_pk_mul_f32 v[82:83], v[78:79], v[78:79] op_sel_hi:[0,1]
  v_pk_fma_f32 v[82:83], v[78:79], v[78:79], v[82:83] op_sel:[1,1,0] op_sel_hi:[1,0,1] neg_lo:[0,1,0]
  v_cvt_pk_bf16_f32 v95, v86, -v87
  ds_write_b32 v27, v95 offset:0
  v_pk_mul_f32 v[92:93], v[86:87], v[64:65] op_sel_hi:[0,1]
  v_pk_fma_f32 v[92:93], v[86:87], v[64:65], v[92:93] op_sel:[1,1,0] op_sel_hi:[1,0,1] neg_lo:[0,1,0]
  v_cvt_pk_bf16_f32 v96, v92, -v93
  ds_write_b32 v27, v96 offset:272
  v_pk_mul_f32 v[90:91], v[86:87], v[66:67] op_sel_hi:[0,1]
  v_pk_fma_f32 v[90:91], v[86:87], v[66:67], v[90:91] op_sel:[1,1,0] op_sel_hi:[1,0,1] neg_lo:[0,1,0]
  v_cvt_pk_bf16_f32 v97, v90, -v91
  ds_write_b32 v27, v97 offset:544
  v_pk_mul_f32 v[92:93], v[86:87], v[68:69] op_sel_hi:[0,1]
  v_pk_fma_f32 v[92:93], v[86:87], v[68:69], v[92:93] op_sel:[1,1,0] op_sel_hi:[1,0,1] neg_lo:[0,1,0]
  v_cvt_pk_bf16_f32 v94, v92, -v93
  ds_write_b32 v27, v94 offset:816
  v_pk_mul_f32 v[90:91], v[86:87], v[70:71] op_sel_hi:[0,1]
  v_pk_fma_f32 v[90:91], v[86:87], v[70:71], v[90:91] op_sel:[1,1,0] op_sel_hi:[1,0,1] neg_lo:[0,1,0]
  v_cvt_pk_bf16_f32 v95, v90, -v91
  ds_write_b32 v27, v95 offset:1088
  v_pk_mul_f32 v[92:93], v[86:87], v[72:73] op_sel_hi:[0,1]
  v_pk_fma_f32 v[92:93], v[86:87], v[72:73], v[92:93] op_sel:[1,1,0] op_sel_hi:[1,0,1] neg_lo:[0,1,0]
  v_cvt_pk_bf16_f32 v96, v92, -v93
  ds_write_b32 v27, v96 offset:1360
  v_pk_mul_f32 v[90:91], v[86:87], v[74:75] op_sel_hi:[0,1]
  v_pk_fma_f32 v[90:91], v[86:87], v[74:75], v[90:91] op_sel:[1,1,0] op_sel_hi:[1,0,1] neg_lo:[0,1,0]
  v_cvt_pk_bf16_f32 v97, v90, -v91
  ds_write_b32 v27, v97 offset:1632
  v_pk_mul_f32 v[92:93], v[86:87], v[76:77] op_sel_hi:[0,1]
  v_pk_fma_f32 v[92:93], v[86:87], v[76:77], v[92:93] op_sel:[1,1,0] op_sel_hi:[1,0,1] neg_lo:[0,1,0]
  v_cvt_pk_bf16_f32 v94, v92, -v93
  ds_write_b32 v27, v94 offset:1904
  v_cvt_pk_bf16_f32 v95, v82, v83
  ds_write_b32 v27, v95 offset:11696
  v_pk_mul_f32 v[86:87], v[88:89], v[80:81] op_sel_hi:[0,1]
  v_pk_fma_f32 v[86:87], v[88:89], v[80:81], v[86:87] op_sel:[1,1,0] op_sel_hi:[1,0,1] neg_lo:[0,1,0]
  v_pk_mul_f32 v[84:85], v[82:83], v[78:79] op_sel_hi:[0,1]
  v_pk_fma_f32 v[84:85], v[82:83], v[78:79], v[84:85] op_sel:[1,1,0] op_sel_hi:[1,0,1] neg_lo:[0,1,0]
  v_cvt_pk_bf16_f32 v96, v88, -v89
  ds_write_b32 v27, v96 offset:2176
  v_pk_mul_f32 v[92:93], v[88:89], v[64:65] op_sel_hi:[0,1]
  v_pk_fma_f32 v[92:93], v[88:89], v[64:65], v[92:93] op_sel:[1,1,0] op_sel_hi:[1,0,1] neg_lo:[0,1,0]
  v_cvt_pk_bf16_f32 v97, v92, -v93
  ds_write_b32 v27, v97 offset:2448
  v_pk_mul_f32 v[90:91], v[88:89], v[66:67] op_sel_hi:[0,1]
  v_pk_fma_f32 v[90:91], v[88:89], v[66:67], v[90:91] op_sel:[1,1,0] op_sel_hi:[1,0,1] neg_lo:[0,1,0]
  v_cvt_pk_bf16_f32 v94, v90, -v91
  ds_write_b32 v27, v94 offset:2720
  v_pk_mul_f32 v[92:93], v[88:89], v[68:69] op_sel_hi:[0,1]
  v_pk_fma_f32 v[92:93], v[88:89], v[68:69], v[92:93] op_sel:[1,1,0] op_sel_hi:[1,0,1] neg_lo:[0,1,0]
  v_cvt_pk_bf16_f32 v95, v92, -v93
  ds_write_b32 v27, v95 offset:2992
  v_pk_mul_f32 v[90:91], v[88:89], v[70:71] op_sel_hi:[0,1]
  v_pk_fma_f32 v[90:91], v[88:89], v[70:71], v[90:91] op_sel:[1,1,0] op_sel_hi:[1,0,1] neg_lo:[0,1,0]
  v_cvt_pk_bf16_f32 v96, v90, -v91
  ds_write_b32 v27, v96 offset:3264
  v_pk_mul_f32 v[92:93], v[88:89], v[72:73] op_sel_hi:[0,1]
  v_pk_fma_f32 v[92:93], v[88:89], v[72:73], v[92:93] op_sel:[1,1,0] op_sel_hi:[1,0,1] neg_lo:[0,1,0]
  v_cvt_pk_bf16_f32 v97, v92, -v93
  ds_write_b32 v27, v97 offset:3536
  v_pk_mul_f32 v[90:91], v[88:89], v[74:75] op_sel_hi:[0,1]
  v_pk_fma_f32 v[90:91], v[88:89], v[74:75], v[90:91] op_sel:[1,1,0] op_sel_hi:[1,0,1] neg_lo:[0,1,0]
  v_cvt_pk_bf16_f32 v94, v90, -v91
  ds_write_b32 v27, v94 offset:3808
  v_pk_mul_f32 v[92:93], v[88:89], v[76:77] op_sel_hi:[0,1]
  v_pk_fma_f32 v[92:93], v[88:89], v[76:77], v[92:93] op_sel:[1,1,0] op_sel_hi:[1,0,1] neg_lo:[0,1,0]
  v_cvt_pk_bf16_f32 v95, v92, -v93
  ds_write_b32 v27, v95 offset:4080
  v_cvt_pk_bf16_f32 v96, v84, v85
  ds_write_b32 v27, v96 offset:11968
  v_pk_mul_f32 v[88:89], v[86:87], v[80:81] op_sel_hi:[0,1]
  v_pk_fma_f32 v[88:89], v[86:87], v[80:81], v[88:89] op_sel:[1,1,0] op_sel_hi:[1,0,1] neg_lo:[0,1,0]
  v_pk_mul_f32 v[82:83], v[84:85], v[78:79] op_sel_hi:[0,1]
  v_pk_fma_f32 v[82:83], v[84:85], v[78:79], v[82:83] op_sel:[1,1,0] op_sel_hi:[1,0,1] neg_lo:[0,1,0]
  v_cvt_pk_bf16_f32 v97, v86, -v87
  ds_write_b32 v27, v97 offset:4352
  v_pk_mul_f32 v[92:93], v[86:87], v[66:67] op_sel_hi:[0,1]
  v_pk_fma_f32 v[92:93], v[86:87], v[66:67], v[92:93] op_sel:[1,1,0] op_sel_hi:[1,0,1] neg_lo:[0,1,0]
  v_cvt_pk_bf16_f32 v94, v92, -v93
  ds_write_b32 v27, v94 offset:4624
  v_pk_mul_f32 v[90:91], v[86:87], v[70:71] op_sel_hi:[0,1]
  v_pk_fma_f32 v[90:91], v[86:87], v[70:71], v[90:91] op_sel:[1,1,0] op_sel_hi:[1,0,1] neg_lo:[0,1,0]
  v_cvt_pk_bf16_f32 v95, v90, -v91
  ds_write_b32 v27, v95 offset:4896
  v_pk_mul_f32 v[92:93], v[86:87], v[74:75] op_sel_hi:[0,1]
  v_pk_fma_f32 v[92:93], v[86:87], v[74:75], v[92:93] op_sel:[1,1,0] op_sel_hi:[1,0,1] neg_lo:[0,1,0]
  v_cvt_pk_bf16_f32 v96, v92, -v93
  ds_write_b32 v27, v96 offset:5168
  v_cvt_pk_bf16_f32 v97, v82, v83
  ds_write_b32 v27, v97 offset:12240
  v_pk_mul_f32 v[86:87], v[88:89], v[80:81] op_sel_hi:[0,1]
  v_pk_fma_f32 v[86:87], v[88:89], v[80:81], v[86:87] op_sel:[1,1,0] op_sel_hi:[1,0,1] neg_lo:[0,1,0]
  v_pk_mul_f32 v[84:85], v[82:83], v[78:79] op_sel_hi:[0,1]
  v_pk_fma_f32 v[84:85], v[82:83], v[78:79], v[84:85] op_sel:[1,1,0] op_sel_hi:[1,0,1] neg_lo:[0,1,0]
  v_cvt_pk_bf16_f32 v94, v88, -v89
  ds_write_b32 v27, v94 offset:5440
  v_pk_mul_f32 v[92:93], v[88:89], v[66:67] op_sel_hi:[0,1]
  v_pk_fma_f32 v[92:93], v[88:89], v[66:67], v[92:93] op_sel:[1,1,0] op_sel_hi:[1,0,1] neg_lo:[0,1,0]
  v_cvt_pk_bf16_f32 v95, v92, -v93
  ds_write_b32 v27, v95 offset:5712
  v_pk_mul_f32 v[90:91], v[88:89], v[70:71] op_sel_hi:[0,1]
  v_pk_fma_f32 v[90:91], v[88:89], v[70:71], v[90:91] op_sel:[1,1,0] op_sel_hi:[1,0,1] neg_lo:[0,1,0]
  v_cvt_pk_bf16_f32 v96, v90, -v91
  ds_write_b32 v27, v96 offset:5984
  v_pk_mul_f32 v[92:93], v[88:89], v[74:75] op_sel_hi:[0,1]
  v_pk_fma_f32 v[92:93], v[88:89], v[74:75], v[92:93] op_sel:[1,1,0] op_sel_hi:[1,0,1] neg_lo:[0,1,0]
  v_cvt_pk_bf16_f32 v97, v92, -v93
  ds_write_b32 v27, v97 offset:6256
  v_cvt_pk_bf16_f32 v94, v84, v85
  ds_write_b32 v27, v94 offset:12512
  v_pk_mul_f32 v[88:89], v[86:87], v[80:81] op_sel_hi:[0,1]
  v_pk_fma_f32 v[88:89], v[86:87], v[80:81], v[88:89] op_sel:[1,1,0] op_sel_hi:[1,0,1] neg_lo:[0,1,0]
  v_pk_mul_f32 v[82:83], v[84:85], v[78:79] op_sel_hi:[0,1]
  v_pk_fma_f32 v[82:83], v[84:85], v[78:79], v[82:83] op_sel:[1,1,0] op_sel_hi:[1,0,1] neg_lo:[0,1,0]
  v_cvt_pk_bf16_f32 v95, v86, -v87
  ds_write_b32 v27, v95 offset:6528
  v_pk_mul_f32 v[90:91], v[86:87], v[70:71] op_sel_hi:[0,1]
  v_pk_fma_f32 v[90:91], v[86:87], v[70:71], v[90:91] op_sel:[1,1,0] op_sel_hi:[1,0,1] neg_lo:[0,1,0]
  v_cvt_pk_bf16_f32 v96, v90, -v91
  ds_write_b32 v27, v96 offset:6800
  v_cvt_pk_bf16_f32 v97, v82, v83
  ds_write_b32 v27, v97 offset:12784
  v_pk_mul_f32 v[86:87], v[88:89], v[80:81] op_sel_hi:[0,1]
  v_pk_fma_f32 v[86:87], v[88:89], v[80:81], v[86:87] op_sel:[1,1,0] op_sel_hi:[1,0,1] neg_lo:[0,1,0]
  v_pk_mul_f32 v[84:85], v[82:83], v[78:79] op_sel_hi:[0,1]
  v_pk_fma_f32 v[84:85], v[82:83], v[78:79], v[84:85] op_sel:[1,1,0] op_sel_hi:[1,0,1] neg_lo:[0,1,0]
  v_cvt_pk_bf16_f32 v94, v88, -v89
  ds_write_b32 v27, v94 offset:7072
  v_pk_mul_f32 v[90:91], v[88:89], v[70:71] op_sel_hi:[0,1]
  v_pk_fma_f32 v[90:91], v[88:89], v[70:71], v[90:91] op_sel:[1,1,0] op_sel_hi:[1,0,1] neg_lo:[0,1,0]
  v_cvt_pk_bf16_f32 v95, v90, -v91
  ds_write_b32 v27, v95 offset:7344
  v_cvt_pk_bf16_f32 v96, v84, v85
  ds_write_b32 v27, v96 offset:13056
  v_pk_mul_f32 v[88:89], v[86:87], v[80:81] op_sel_hi:[0,1]
  v_pk_fma_f32 v[88:89], v[86:87], v[80:81], v[88:89] op_sel:[1,1,0] op_sel_hi:[1,0,1] neg_lo:[0,1,0]
  v_pk_mul_f32 v[82:83], v[84:85], v[78:79] op_sel_hi:[0,1]
  v_pk_fma_f32 v[82:83], v[84:85], v[78:79], v[82:83] op_sel:[1,1,0] op_sel_hi:[1,0,1] neg_lo:[0,1,0]
  v_cvt_pk_bf16_f32 v97, v86, -v87
  ds_write_b32 v27, v97 offset:7616
  v_pk_mul_f32 v[90:91], v[86:87], v[70:71] op_sel_hi:[0,1]
  v_pk_fma_f32 v[90:91], v[86:87], v[70:71], v[90:91] op_sel:[1,1,0] op_sel_hi:[1,0,1] neg_lo:[0,1,0]
  v_cvt_pk_bf16_f32 v94, v90, -v91
  ds_write_b32 v27, v94 offset:7888
  v_cvt_pk_bf16_f32 v95, v82, v83
  ds_write_b32 v27, v95 offset:13328
  v_pk_mul_f32 v[86:87], v[88:89], v[80:81] op_sel_hi:[0,1]
  v_pk_fma_f32 v[86:87], v[88:89], v[80:81], v[86:87] op_sel:[1,1,0] op_sel_hi:[1,0,1] neg_lo:[0,1,0]
  v_pk_mul_f32 v[84:85], v[82:83], v[78:79] op_sel_hi:[0,1]
  v_pk_fma_f32 v[84:85], v[82:83], v[78:79], v[84:85] op_sel:[1,1,0] op_sel_hi:[1,0,1] neg_lo:[0,1,0]
  v_cvt_pk_bf16_f32 v96, v88, -v89
  ds_write_b32 v27, v96 offset:8160
  v_pk_mul_f32 v[90:91], v[88:89], v[70:71] op_sel_hi:[0,1]
  v_pk_fma_f32 v[90:91], v[88:89], v[70:71], v[90:91] op_sel:[1,1,0] op_sel_hi:[1,0,1] neg_lo:[0,1,0]
  v_cvt_pk_bf16_f32 v97, v90, -v91
  ds_write_b32 v27, v97 offset:8432
  v_cvt_pk_bf16_f32 v94, v84, v85
  ds_write_b32 v27, v94 offset:13600
  v_pk_mul_f32 v[88:89], v[86:87], v[80:81] op_sel_hi:[0,1]
  v_pk_fma_f32 v[88:89], v[86:87], v[80:81], v[88:89] op_sel:[1,1,0] op_sel_hi:[1,0,1] neg_lo:[0,1,0]
  v_pk_mul_f32 v[82:83], v[84:85], v[78:79] op_sel_hi:[0,1]
  v_pk_fma_f32 v[82:83], v[84:85], v[78:79], v[82:83] op_sel:[1,1,0] op_sel_hi:[1,0,1] neg_lo:[0,1,0]
  v_cvt_pk_bf16_f32 v95, v86, -v87
  ds_write_b32 v27, v95 offset:8704
  v_cvt_pk_bf16_f32 v96, v82, v83
  ds_write_b32 v27, v96 offset:13872
  v_pk_mul_f32 v[86:87], v[88:89], v[80:81] op_sel_hi:[0,1]
  v_pk_fma_f32 v[86:87], v[88:89], v[80:81], v[86:87] op_sel:[1,1,0] op_sel_hi:[1,0,1] neg_lo:[0,1,0]
  v_pk_mul_f32 v[84:85], v[82:83], v[78:79] op_sel_hi:[0,1]
  v_pk_fma_f32 v[84:85], v[82:83], v[78:79], v[84:85] op_sel:[1,1,0] op_sel_hi:[1,0,1] neg_lo:[0,1,0]
  v_cvt_pk_bf16_f32 v97, v88, -v89
  ds_write_b32 v27, v97 offset:8976
  v_cvt_pk_bf16_f32 v94, v84, v85
  ds_write_b32 v27, v94 offset:14144
  v_pk_mul_f32 v[88:89], v[86:87], v[80:81] op_sel_hi:[0,1]
  v_pk_fma_f32 v[88:89], v[86:87], v[80:81], v[88:89] op_sel:[1,1,0] op_sel_hi:[1,0,1] neg_lo:[0,1,0]
  v_pk_mul_f32 v[82:83], v[84:85], v[78:79] op_sel_hi:[0,1]
  v_pk_fma_f32 v[82:83], v[84:85], v[78:79], v[82:83] op_sel:[1,1,0] op_sel_hi:[1,0,1] neg_lo:[0,1,0]
  v_cvt_pk_bf16_f32 v95, v86, -v87
  ds_write_b32 v27, v95 offset:9248
  v_cvt_pk_bf16_f32 v96, v82, v83
  ds_write_b32 v27, v96 offset:14416
  v_pk_mul_f32 v[86:87], v[88:89], v[80:81] op_sel_hi:[0,1]
  v_pk_fma_f32 v[86:87], v[88:89], v[80:81], v[86:87] op_sel:[1,1,0] op_sel_hi:[1,0,1] neg_lo:[0,1,0]
  v_pk_mul_f32 v[84:85], v[82:83], v[78:79] op_sel_hi:[0,1]
  v_pk_fma_f32 v[84:85], v[82:83], v[78:79], v[84:85] op_sel:[1,1,0] op_sel_hi:[1,0,1] neg_lo:[0,1,0]
  v_cvt_pk_bf16_f32 v97, v88, -v89
  ds_write_b32 v27, v97 offset:9520
  v_cvt_pk_bf16_f32 v94, v84, v85
  ds_write_b32 v27, v94 offset:14688
  v_pk_mul_f32 v[88:89], v[86:87], v[80:81] op_sel_hi:[0,1]
  v_pk_fma_f32 v[88:89], v[86:87], v[80:81], v[88:89] op_sel:[1,1,0] op_sel_hi:[1,0,1] neg_lo:[0,1,0]
  v_pk_mul_f32 v[82:83], v[84:85], v[78:79] op_sel_hi:[0,1]
  v_pk_fma_f32 v[82:83], v[84:85], v[78:79], v[82:83] op_sel:[1,1,0] op_sel_hi:[1,0,1] neg_lo:[0,1,0]
  v_cvt_pk_bf16_f32 v95, v86, -v87
  ds_write_b32 v27, v95 offset:9792
  v_cvt_pk_bf16_f32 v96, v82, v83
  ds_write_b32 v27, v96 offset:14960
  v_pk_mul_f32 v[86:87], v[88:89], v[80:81] op_sel_hi:[0,1]
  v_pk_fma_f32 v[86:87], v[88:89], v[80:81], v[86:87] op_sel:[1,1,0] op_sel_hi:[1,0,1] neg_lo:[0,1,0]
  v_pk_mul_f32 v[84:85], v[82:83], v[78:79] op_sel_hi:[0,1]
  v_pk_fma_f32 v[84:85], v[82:83], v[78:79], v[84:85] op_sel:[1,1,0] op_sel_hi:[1,0,1] neg_lo:[0,1,0]
  v_cvt_pk_bf16_f32 v97, v88, -v89
  ds_write_b32 v27, v97 offset:10064
  v_cvt_pk_bf16_f32 v94, v84, v85
  ds_write_b32 v27, v94 offset:15232
  v_pk_mul_f32 v[88:89], v[86:87], v[80:81] op_sel_hi:[0,1]
  v_pk_fma_f32 v[88:89], v[86:87], v[80:81], v[88:89] op_sel:[1,1,0] op_sel_hi:[1,0,1] neg_lo:[0,1,0]
  v_cvt_pk_bf16_f32 v95, v86, -v87
  ds_write_b32 v27, v95 offset:10336
  v_pk_mul_f32 v[86:87], v[88:89], v[80:81] op_sel_hi:[0,1]
  v_pk_fma_f32 v[86:87], v[88:89], v[80:81], v[86:87] op_sel:[1,1,0] op_sel_hi:[1,0,1] neg_lo:[0,1,0]
  v_cvt_pk_bf16_f32 v96, v88, -v89
  ds_write_b32 v27, v96 offset:10608
  v_cvt_pk_bf16_f32 v97, v86, -v87
  ds_write_b32 v27, v97 offset:10880
  v_lshrrev_b32 v224, 16, v224
  v_lshrrev_b32 v225, 16, v225
  v_lshrrev_b32 v226, 16, v226
  v_lshrrev_b32 v227, 16, v227
  ds_read_b128 v[124:127], v26 offset:11152
  ds_read_b128 v[112:115], v26 offset:0
  ds_read_b128 v[116:119], v26 offset:4352
  ds_read_b128 v[120:123], v26 offset:8704
  ds_read_b128 v[140:143], v26 offset:11216
  ds_read_b128 v[128:131], v26 offset:64
  ds_read_b128 v[132:135], v26 offset:4416
  ds_read_b128 v[136:139], v26 offset:8768
  ds_read_b128 v[156:159], v26 offset:11280
  ds_read_b128 v[144:147], v26 offset:128
  ds_read_b128 v[148:151], v26 offset:4480
  ds_read_b128 v[152:155], v26 offset:8832
  s_waitcnt lgkmcnt(8)
  ds_read_b128 v[172:175], v26 offset:11344
  ds_read_b128 v[160:163], v26 offset:192
  ds_read_b128 v[164:167], v26 offset:4544
  ds_read_b128 v[168:171], v26 offset:8896
  s_waitcnt lgkmcnt(12)
  v_mfma_f32_16x16x32_bf16 v[100:103], v[112:115], v[124:127], v[100:103]
  v_mfma_f32_16x16x32_bf16 v[104:107], v[116:119], v[124:127], v[104:107]
  v_mfma_f32_16x16x32_bf16 v[108:111], v[120:123], v[124:127], v[108:111]
  s_waitcnt lgkmcnt(8)
  v_mfma_f32_16x16x32_bf16 v[100:103], v[128:131], v[140:143], v[100:103]
  v_mfma_f32_16x16x32_bf16 v[104:107], v[132:135], v[140:143], v[104:107]
  v_mfma_f32_16x16x32_bf16 v[108:111], v[136:139], v[140:143], v[108:111]
  s_waitcnt lgkmcnt(4)
  v_mfma_f32_16x16x32_bf16 v[100:103], v[144:147], v[156:159], v[100:103]
  v_mfma_f32_16x16x32_bf16 v[104:107], v[148:151], v[156:159], v[104:107]
  v_mfma_f32_16x16x32_bf16 v[108:111], v[152:155], v[156:159], v[108:111]
  s_waitcnt lgkmcnt(0)
  v_mfma_f32_16x16x32_bf16 v[100:103], v[160:163], v[172:175], v[100:103]
  v_mfma_f32_16x16x32_bf16 v[104:107], v[164:167], v[172:175], v[104:107]
  v_mfma_f32_16x16x32_bf16 v[108:111], v[168:171], v[172:175], v[108:111]
  s_cmp_lg_u32 s35, 1
  s_cbranch_scc1 L_cv_have
  s_mov_b32 s35, 0
  v_mul_u32_u24 v61, 256, v1
  s_mov_b32 s61, 0x100000
L_cvln3_poll:
  s_mov_b32 s62, 196608
  buffer_load_dwordx4 v[180:183], v61, s[8:11], s62 offen sc1
  s_sub_u32 s61, s61, 1
  s_cbranch_scc1 L_cvln3_go
  s_waitcnt vmcnt(0)
  v_xor_b32 v180, s101, v180
  v_xor_b32 v181, s101, v181
  v_xor_b32 v182, s101, v182
  v_xor_b32 v183, s101, v183
  v_or3_b32 v180, v180, v181, v182
  v_or_b32 v180, v180, v183
  v_cmp_ne_u32 vcc, 0, v180
  s_nop 0
  s_cmp_eq_u64 vcc, 0
  s_cbranch_scc1 L_cvln3_go
  s_sleep 4
  s_branch L_cvln3_poll
L_cvln3_go:
  v_lshrrev_b32 v4, 4, v1
  v_add_u32 v4, s31, v4
  v_lshrrev_b32 v5, 4, v4
  v_and_b32 v4, 15, v4
  v_lshlrev_b32 v4, 4, v4
  v_lshl_add_u32 v4, v5, 16, v4
  v_and_b32 v5, 15, v1
  v_lshl_add_u32 v2, v5, 8, v4
  s_lshl_b32 s32, s30, 4
  s_lshl_b64 s[32:33], 1, s32
  s_sub_u32 s32, s32, 1
  s_subb_u32 s33, s33, 0
  s_mov_b64 exec, s[32:33]
  s_add_u32 m0, s34, 17040
  s_mov_b32 s33, 0
  buffer_load_dwordx4 v2, s[16:19], s33 offen lds
  s_add_u32 m0, s34, 17808
  s_mov_b32 s33, 4096
  buffer_load_dwordx4 v2, s[16:19], s33 offen lds
  s_add_u32 m0, s34, 18576
  s_mov_b32 s33, 8192
  buffer_load_dwordx4 v2, s[16:19], s33 offen lds
  s_add_u32 m0, s34, 19344
  s_mov_b32 s33, 12288
  buffer_load_dwordx4 v2, s[16:19], s33 offen lds
  s_add_u32 m0, s34, 20112
  s_mov_b32 s33, 16384
  buffer_load_dwordx4 v2, s[16:19], s33 offen lds
  s_add_u32 m0, s34, 20880
  s_mov_b32 s33, 20480
  buffer_load_dwordx4 v2, s[16:19], s33 offen lds
  s_add_u32 m0, s34, 21648
  s_mov_b32 s33, 24576
  buffer_load_dwordx4 v2, s[16:19], s33 offen lds
  s_add_u32 m0, s34, 22416
  s_mov_b32 s33, 28672
  buffer_load_dwordx4 v2, s[16:19], s33 offen lds
  s_add_u32 m0, s34, 23184
  s_mov_b32 s33, 32768
  buffer_load_dwordx4 v2, s[16:19], s33 offen lds
  s_add_u32 m0, s34, 23952
  s_mov_b32 s33, 36864
  buffer_load_dwordx4 v2, s[16:19], s33 offen lds
  s_add_u32 m0, s34, 24720
  s_mov_b32 s33, 40960
  buffer_load_dwordx4 v2, s[16:19], s33 offen lds
  s_add_u32 m0, s34, 25488
  s_mov_b32 s33, 45056
  buffer_load_dwordx4 v2, s[16:19], s33 offen lds
  s_add_u32 m0, s34, 26256
  s_mov_b32 s33, 49152
  buffer_load_dwordx4 v2, s[16:19], s33 offen lds
  s_add_u32 m0, s34, 27024
  s_mov_b32 s33, 53248
  buffer_load_dwordx4 v2, s[16:19], s33 offen lds
  s_add_u32 m0, s34, 27792
  s_mov_b32 s33, 57344
  buffer_load_dwordx4 v2, s[16:19], s33 offen lds
  s_add_u32 m0, s34, 28560
  s_mov_b32 s33, 61440
  buffer_load_dwordx4 v2, s[16:19], s33 offen lds
  s_mov_b64 exec, -1
L_cv_have:
  s_add_u32 s41, s41, 1
  s_cmp_lt_u32 s41, 2
  s_cbranch_scc1 L_cv_half
  v_pk_mov_b32 v[224:225], v[228:229], v[228:229] op_sel:[0,1]
  v_pk_mov_b32 v[226:227], v[230:231], v[230:231] op_sel:[0,1]
  v_pk_mov_b32 v[228:229], v[232:233], v[232:233] op_sel:[0,1]
  v_pk_mov_b32 v[230:231], v[234:235], v[234:235] op_sel:[0,1]
  v_mov_b32 v4, 0
  v_mov_b32 v5, 0
  ds_write_b64 v49, v[4:5] offset:4160
  ds_write_b64 v49, v[4:5] offset:8320
  v_mov_b32_dpp v80, v108 quad_perm:[0,0,2,2] row_mask:0xf bank_mask:0xf
  v_cvt_pk_bf16_f32 v64, v108, v108
  v_cvt_pk_bf16_f32 v67, v108, v80
  v_mov_b32 v65, v64
  v_mov_b32 v66, v64
  v_mov_b32_dpp v81, v109 quad_perm:[0,0,2,2] row_mask:0xf bank_mask:0xf
  v_cvt_pk_bf16_f32 v68, v109, v109
  v_cvt_pk_bf16_f32 v71, v109, v81
  v_mov_b32 v69, v68
  v_mov_b32 v70, v68
  v_mov_b32_dpp v82, v110 quad_perm:[0,0,2,2] row_mask:0xf bank_mask:0xf
  v_cvt_pk_bf16_f32 v72, v110, v110
  v_cvt_pk_bf16_f32 v75, v110, v82
  v_mov_b32 v73, v72
  v_mov_b32 v74, v72
  v_mov_b32_dpp v83, v111 quad_perm:[0,0,2,2] row_mask:0xf bank_mask:0xf
  v_cvt_pk_bf16_f32 v76, v111, v111
  v_cvt_pk_bf16_f32 v79, v111, v83
  v_mov_b32 v77, v76
  v_mov_b32 v78, v76
  s_mov_b32 exec_hi, 1
  ds_write2_b64 v44, v[64:65], v[66:67] offset0:96 offset1:97
  s_mov_b32 exec_hi, 0
  ds_write2_b64 v44, v[68:69], v[70:71] offset0:64 offset1:65
  s_mov_b32 exec_hi, 0
  ds_write2_b64 v44, v[72:73], v[74:75] offset0:32 offset1:33
  s_mov_b32 exec_hi, 0
  ds_write2_b64 v44, v[76:77], v[78:79] offset0:0 offset1:1
  s_mov_b32 exec_hi, -1
  v_cvt_pk_bf16_f32 v84, v105, v105
  v_cvt_pk_bf16_f32 v85, v105, v104
  v_cvt_pk_bf16_f32 v86, v104, v104
  v_cvt_pk_bf16_f32 v87, v107, v107
  v_cvt_pk_bf16_f32 v88, v107, v106
  v_cvt_pk_bf16_f32 v89, v106, v106
  v_cvt_pk_bf16_f32 v90, v107, v107
  v_cvt_pk_bf16_f32 v91, v106, v106
  v_cvt_pk_bf16_f32 v92, v106, v105
  v_cvt_pk_bf16_f32 v93, v104, v104
  v_cvt_pk_bf16_f32 v94, v103, v102
  v_cvt_pk_bf16_f32 v95, v101, v100
  s_mov_b32 exec_lo, 0
  ds_write2_b32 v45, v84, v85 offset0:64 offset1:65
  ds_write2_b32 v45, v86, v86 offset0:66 offset1:67
  ds_write2_b32 v45, v87, v88 offset0:0 offset1:1
  ds_write2_b32 v45, v89, v89 offset0:2 offset1:3
  s_mov_b32 exec_lo, -1
  s_mov_b32 exec_hi, 0
  ds_write_b16 v46, v90
  ds_write2_b32 v47, v91, v92 offset0:0 offset1:1
  ds_write_b32 v47, v93 offset:8
  ds_write_b16 v46, v93 offset:14
  s_mov_b32 exec_hi, -1
  ds_write_b64 v48, v[94:95]
  v_lshl_add_u32 v9, v1, 4, s34
  ds_read_b128 v[64:67], v9 offset:64
  ds_read_b32 v80, v9 offset:80
  ds_read_b128 v[68:71], v9 offset:1088
  ds_read_b32 v81, v9 offset:1104
  ds_read_b128 v[72:75], v9 offset:2112
  ds_read_b32 v82, v9 offset:2128
  ds_read_b128 v[76:79], v9 offset:3136
  ds_read_b32 v83, v9 offset:3152
  s_waitcnt lgkmcnt(6)
  v_alignbit_b32 v84, v65, v64, 16
  v_alignbit_b32 v85, v66, v65, 16
  v_alignbit_b32 v86, v67, v66, 16
  v_alignbit_b32 v87, v80, v67, 16
  ds_write_b128 v9, v[84:87] offset:4224
  s_waitcnt lgkmcnt(5)
  v_alignbit_b32 v88, v69, v68, 16
  v_alignbit_b32 v89, v70, v69, 16
  v_alignbit_b32 v90, v71, v70, 16
  v_alignbit_b32 v91, v81, v71, 16
  ds_write_b128 v9, v[88:91] offset:5248
  s_waitcnt lgkmcnt(4)
  v_alignbit_b32 v92, v73, v72, 16
  v_alignbit_b32 v93, v74, v73, 16
  v_alignbit_b32 v94, v75, v74, 16
  v_alignbit_b32 v95, v82, v75, 16
  ds_write_b128 v9, v[92:95] offset:6272
  s_waitcnt lgkmcnt(3)
  v_alignbit_b32 v96, v77, v76, 16
  v_alignbit_b32 v97, v78, v77, 16
  v_alignbit_b32 v98, v79, v78, 16
  v_alignbit_b32 v99, v83, v79, 16
  ds_write_b128 v9, v[96:99] offset:7296
  v_readlane_b32 s40, v249, s38
  s_nop 0
  s_lshl_b32 s41, s40, 16
  s_or_b32 s40, s40, s41
  v_and_b32 v32, s40, v28
  v_and_b32 v33, s40, v29
  v_and_b32 v34, s40, v30
  v_and_b32 v35, s40, v31
  s_lshl_b32 s39, s31, 12
  s_add_u32 s31, s31, 1
  s_waitcnt vmcnt(0) lgkmcnt(0)
  ds_read2_b32 v[64:65], v20 offset0:240 offset1:241
  ds_read2_b32 v[66:67], v20 offset0:242 offset1:243
  ds_read_b128 v[96:99], v50 offset:0
  ds_read_b128 v[100:103], v50 offset:1536
  ds_read_b128 v[104:107], v50 offset:3072
  ds_read_b128 v[108:111], v50 offset:4608
  ds_read_b128 v[112:115], v50 offset:6144
  ds_read_b128 v[116:119], v50 offset:7680
  ds_read_b128 v[120:123], v50 offset:9216
  ds_read_b128 v[124:127], v50 offset:10752
  ds_read2_b32 v[68:69], v20 offset0:112 offset1:113
  ds_read2_b32 v[70:71], v20 offset0:114 offset1:115
  ds_read2_b32 v[72:73], v21 offset0:240 offset1:241
  ds_read2_b32 v[74:75], v21 offset0:242 offset1:243
  s_waitcnt lgkmcnt(4)
  ds_read2_b32 v[76:77], v21 offset0:112 offset1:113
  ds_read2_b32 v[78:79], v21 offset0:114 offset1:115
  ds_read2_b32 v[80:81], v22 offset0:240 offset1:241
  ds_read2_b32 v[82:83], v22 offset0:242 offset1:243
  ds_read2_b32 v[84:85], v22 offset0:112 offset1:113
  ds_read2_b32 v[86:87], v22 offset0:114 offset1:115
  ds_read2_b32 v[88:89], v23 offset0:240 offset1:241
  ds_read2_b32 v[90:91], v23 offset0:242 offset1:243
  ds_read2_b32 v[92:93], v23 offset0:112 offset1:113
  ds_read2_b32 v[94:95], v23 offset0:114 offset1:115
  v_mfma_f32_16x16x32_bf16 v[192:195], v[64:67], v[96:99], 0
  v_mfma_f32_16x16x32_bf16 v[196:199], v[64:67], v[100:103], 0
  v_mfma_f32_16x16x32_bf16 v[200:203], v[64:67], v[104:107], 0
  v_mfma_f32_16x16x32_bf16 v[204:207], v[64:67], v[108:111], 0
  v_mfma_f32_16x16x32_bf16 v[208:211], v[64:67], v[112:115], 0
  v_mfma_f32_16x16x32_bf16 v[212:215], v[64:67], v[116:119], 0
  v_mfma_f32_16x16x32_bf16 v[216:219], v[64:67], v[120:123], 0
  v_mfma_f32_16x16x32_bf16 v[220:223], v[64:67], v[124:127], 0
  v_mfma_f32_16x16x32_bf16 v[192:195], v[32:35], v[96:99], v[192:195]
  v_mfma_f32_16x16x32_bf16 v[196:199], v[32:35], v[100:103], v[196:199]
  v_mfma_f32_16x16x32_bf16 v[200:203], v[32:35], v[104:107], v[200:203]
  v_mfma_f32_16x16x32_bf16 v[204:207], v[32:35], v[108:111], v[204:207]
  v_mfma_f32_16x16x32_bf16 v[208:211], v[32:35], v[112:115], v[208:211]
  v_mfma_f32_16x16x32_bf16 v[212:215], v[32:35], v[116:119], v[212:215]
  v_mfma_f32_16x16x32_bf16 v[216:219], v[32:35], v[120:123], v[216:219]
  s_waitcnt lgkmcnt(0)
  v_mfma_f32_16x16x32_bf16 v[220:223], v[32:35], v[124:127], v[220:223]
  ds_read2_b32 v[128:129], v20 offset0:224 offset1:225
  v_mfma_f32_16x16x32_bf16 v[196:199], v[68:71], v[96:99], v[196:199]
  ds_read2_b32 v[130:131], v20 offset0:226 offset1:227
  v_mfma_f32_16x16x32_bf16 v[200:203], v[68:71], v[100:103], v[200:203]
  ds_read_b128 v[160:163], v51 offset:0
  v_mfma_f32_16x16x32_bf16 v[204:207], v[68:71], v[104:107], v[204:207]
  ds_read_b128 v[164:167], v51 offset:1536
  v_mfma_f32_16x16x32_bf16 v[208:211], v[68:71], v[108:111], v[208:211]
  ds_read_b128 v[168:171], v51 offset:3072
  v_mfma_f32_16x16x32_bf16 v[212:215], v[68:71], v[112:115], v[212:215]
  ds_read_b128 v[172:175], v51 offset:4608
  v_mfma_f32_16x16x32_bf16 v[216:219], v[68:71], v[116:119], v[216:219]
  ds_read_b128 v[176:179], v51 offset:6144
  v_mfma_f32_16x16x32_bf16 v[220:223], v[68:71], v[120:123], v[220:223]
  ds_read_b128 v[180:183], v51 offset:7680
  v_mfma_f32_16x16x32_bf16 v[200:203], v[72:75], v[96:99], v[200:203]
  ds_read_b128 v[184:187], v51 offset:9216
  v_mfma_f32_16x16x32_bf16 v[204:207], v[72:75], v[100:103], v[204:207]
  ds_read_b128 v[188:191], v51 offset:10752
  v_mfma_f32_16x16x32_bf16 v[208:211], v[72:75], v[104:107], v[208:211]
  ds_read2_b32 v[132:133], v20 offset0:96 offset1:97
  v_mfma_f32_16x16x32_bf16 v[212:215], v[72:75], v[108:111], v[212:215]
  ds_read2_b32 v[134:135], v20 offset0:98 offset1:99
  v_mfma_f32_16x16x32_bf16 v[216:219], v[72:75], v[112:115], v[216:219]
  ds_read2_b32 v[136:137], v21 offset0:224 offset1:225
  v_mfma_f32_16x16x32_bf16 v[220:223], v[72:75], v[116:119], v[220:223]
  ds_read2_b32 v[138:139], v21 offset0:226 offset1:227
  v_mfma_f32_16x16x32_bf16 v[204:207], v[76:79], v[96:99], v[204:207]
  ds_read2_b32 v[140:141], v21 offset0:96 offset1:97
  v_mfma_f32_16x16x32_bf16 v[208:211], v[76:79], v[100:103], v[208:211]
  ds_read2_b32 v[142:143], v21 offset0:98 offset1:99
  v_mfma_f32_16x16x32_bf16 v[212:215], v[76:79], v[104:107], v[212:215]
  ds_read2_b32 v[144:145], v22 offset0:224 offset1:225
  v_mfma_f32_16x16x32_bf16 v[216:219], v[76:79], v[108:111], v[216:219]
  ds_read2_b32 v[146:147], v22 offset0:226 offset1:227
  v_mfma_f32_16x16x32_bf16 v[220:223], v[76:79], v[112:115], v[220:223]
  ds_read2_b32 v[148:149], v22 offset0:96 offset1:97
  v_mfma_f32_16x16x32_bf16 v[208:211], v[80:83], v[96:99], v[208:211]
  ds_read2_b32 v[150:151], v22 offset0:98 offset1:99
  v_mfma_f32_16x16x32_bf16 v[212:215], v[80:83], v[100:103], v[212:215]
  ds_read2_b32 v[152:153], v23 offset0:224 offset1:225
  v_mfma_f32_16x16x32_bf16 v[216:219], v[80:83], v[104:107], v[216:219]
  ds_read2_b32 v[154:155], v23 offset0:226 offset1:227
  v_mfma_f32_16x16x32_bf16 v[220:223], v[80:83], v[108:111], v[220:223]
  ds_read2_b32 v[156:157], v23 offset0:96 offset1:97
  v_mfma_f32_16x16x32_bf16 v[212:215], v[84:87], v[96:99], v[212:215]
  ds_read2_b32 v[158:159], v23 offset0:98 offset1:99
  v_mfma_f32_16x16x32_bf16 v[216:219], v[84:87], v[100:103], v[216:219]
  v_mfma_f32_16x16x32_bf16 v[220:223], v[84:87], v[104:107], v[220:223]
  v_mfma_f32_16x16x32_bf16 v[216:219], v[88:91], v[96:99], v[216:219]
  v_mfma_f32_16x16x32_bf16 v[220:223], v[88:91], v[100:103], v[220:223]
  v_mfma_f32_16x16x32_bf16 v[220:223], v[92:95], v[96:99], v[220:223]
  s_waitcnt lgkmcnt(0)
  v_mfma_f32_16x16x32_bf16 v[192:195], v[128:131], v[160:163], v[192:195]
  ds_read2_b32 v[64:65], v20 offset0:208 offset1:209
  v_mfma_f32_16x16x32_bf16 v[196:199], v[128:131], v[164:167], v[196:199]
  ds_read2_b32 v[66:67], v20 offset0:210 offset1:211
  v_mfma_f32_16x16x32_bf16 v[200:203], v[128:131], v[168:171], v[200:203]
  ds_read_b128 v[96:99], v52 offset:0
  v_mfma_f32_16x16x32_bf16 v[204:207], v[128:131], v[172:175], v[204:207]
  ds_read_b128 v[100:103], v52 offset:1536
  v_mfma_f32_16x16x32_bf16 v[208:211], v[128:131], v[176:179], v[208:211]
  ds_read_b128 v[104:107], v52 offset:3072
  v_mfma_f32_16x16x32_bf16 v[212:215], v[128:131], v[180:183], v[212:215]
  ds_read_b128 v[108:111], v52 offset:4608
  v_mfma_f32_16x16x32_bf16 v[216:219], v[128:131], v[184:187], v[216:219]
  ds_read_b128 v[112:115], v52 offset:6144
  v_mfma_f32_16x16x32_bf16 v[220:223], v[128:131], v[188:191], v[220:223]
  ds_read_b128 v[116:119], v52 offset:7680
  v_mfma_f32_16x16x32_bf16 v[196:199], v[132:135], v[160:163], v[196:199]
  ds_read_b128 v[120:123], v52 offset:9216
  v_mfma_f32_16x16x32_bf16 v[200:203], v[132:135], v[164:167], v[200:203]
  ds_read_b128 v[124:127], v52 offset:10752
  v_mfma_f32_16x16x32_bf16 v[204:207], v[132:135], v[168:171], v[204:207]
  ds_read2_b32 v[68:69], v20 offset0:80 offset1:81
  v_mfma_f32_16x16x32_bf16 v[208:211], v[132:135], v[172:175], v[208:211]
  ds_read2_b32 v[70:71], v20 offset0:82 offset1:83
  v_mfma_f32_16x16x32_bf16 v[212:215], v[132:135], v[176:179], v[212:215]
  ds_read2_b32 v[72:73], v21 offset0:208 offset1:209
  v_mfma_f32_16x16x32_bf16 v[216:219], v[132:135], v[180:183], v[216:219]
  ds_read2_b32 v[74:75], v21 offset0:210 offset1:211
  v_mfma_f32_16x16x32_bf16 v[220:223], v[132:135], v[184:187], v[220:223]
  ds_read2_b32 v[76:77], v21 offset0:80 offset1:81
  v_mfma_f32_16x16x32_bf16 v[200:203], v[136:139], v[160:163], v[200:203]
  ds_read2_b32 v[78:79], v21 offset0:82 offset1:83
  v_mfma_f32_16x16x32_bf16 v[204:207], v[136:139], v[164:167], v[204:207]
  ds_read2_b32 v[80:81], v22 offset0:208 offset1:209
  v_mfma_f32_16x16x32_bf16 v[208:211], v[136:139], v[168:171], v[208:211]
  ds_read2_b32 v[82:83], v22 offset0:210 offset1:211
  v_mfma_f32_16x16x32_bf16 v[212:215], v[136:139], v[172:175], v[212:215]
  ds_read2_b32 v[84:85], v22 offset0:80 offset1:81
  v_mfma_f32_16x16x32_bf16 v[216:219], v[136:139], v[176:179], v[216:219]
  ds_read2_b32 v[86:87], v22 offset0:82 offset1:83
  v_mfma_f32_16x16x32_bf16 v[220:223], v[136:139], v[180:183], v[220:223]
  ds_read2_b32 v[88:89], v23 offset0:208 offset1:209
  v_mfma_f32_16x16x32_bf16 v[204:207], v[140:143], v[160:163], v[204:207]
  ds_read2_b32 v[90:91], v23 offset0:210 offset1:211
  v_mfma_f32_16x16x32_bf16 v[208:211], v[140:143], v[164:167], v[208:211]
  ds_read2_b32 v[92:93], v23 offset0:80 offset1:81
  v_mfma_f32_16x16x32_bf16 v[212:215], v[140:143], v[168:171], v[212:215]
  ds_read2_b32 v[94:95], v23 offset0:82 offset1:83
  v_mfma_f32_16x16x32_bf16 v[216:219], v[140:143], v[172:175], v[216:219]
  v_mfma_f32_16x16x32_bf16 v[220:223], v[140:143], v[176:179], v[220:223]
  v_mfma_f32_16x16x32_bf16 v[208:211], v[144:147], v[160:163], v[208:211]
  v_mfma_f32_16x16x32_bf16 v[212:215], v[144:147], v[164:167], v[212:215]
  v_mfma_f32_16x16x32_bf16 v[216:219], v[144:147], v[168:171], v[216:219]
  v_mfma_f32_16x16x32_bf16 v[220:223], v[144:147], v[172:175], v[220:223]
  v_mfma_f32_16x16x32_bf16 v[212:215], v[148:151], v[160:163], v[212:215]
  v_mfma_f32_16x16x32_bf16 v[216:219], v[148:151], v[164:167], v[216:219]
  v_mfma_f32_16x16x32_bf16 v[220:223], v[148:151], v[168:171], v[220:223]
  v_mfma_f32_16x16x32_bf16 v[216:219], v[152:155], v[160:163], v[216:219]
  v_mfma_f32_16x16x32_bf16 v[220:223], v[152:155], v[164:167], v[220:223]
  v_mfma_f32_16x16x32_bf16 v[220:223], v[156:159], v[160:163], v[220:223]
  s_waitcnt lgkmcnt(0)
  v_mfma_f32_16x16x32_bf16 v[192:195], v[64:67], v[96:99], v[192:195]
  ds_read2_b32 v[128:129], v20 offset0:192 offset1:193
  v_mfma_f32_16x16x32_bf16 v[196:199], v[64:67], v[100:103], v[196:199]
  ds_read2_b32 v[130:131], v20 offset0:194 offset1:195
  v_mfma_f32_16x16x32_bf16 v[200:203], v[64:67], v[104:107], v[200:203]
  ds_read_b128 v[160:163], v53 offset:0
  v_mfma_f32_16x16x32_bf16 v[204:207], v[64:67], v[108:111], v[204:207]
  ds_read_b128 v[164:167], v53 offset:1536
  v_mfma_f32_16x16x32_bf16 v[208:211], v[64:67], v[112:115], v[208:211]
  ds_read_b128 v[168:171], v53 offset:3072
  v_mfma_f32_16x16x32_bf16 v[212:215], v[64:67], v[116:119], v[212:215]
  ds_read_b128 v[172:175], v53 offset:4608
  v_mfma_f32_16x16x32_bf16 v[216:219], v[64:67], v[120:123], v[216:219]
  ds_read_b128 v[176:179], v53 offset:6144
  v_mfma_f32_16x16x32_bf16 v[220:223], v[64:67], v[124:127], v[220:223]
  ds_read_b128 v[180:183], v53 offset:7680
  v_mfma_f32_16x16x32_bf16 v[196:199], v[68:71], v[96:99], v[196:199]
  ds_read_b128 v[184:187], v53 offset:9216
  v_mfma_f32_16x16x32_bf16 v[200:203], v[68:71], v[100:103], v[200:203]
  ds_read_b128 v[188:191], v53 offset:10752
  v_mfma_f32_16x16x32_bf16 v[204:207], v[68:71], v[104:107], v[204:207]
  ds_read2_b32 v[132:133], v20 offset0:64 offset1:65
  v_mfma_f32_16x16x32_bf16 v[208:211], v[68:71], v[108:111], v[208:211]
  ds_read2_b32 v[134:135], v20 offset0:66 offset1:67
  v_mfma_f32_16x16x32_bf16 v[212:215], v[68:71], v[112:115], v[212:215]
  ds_read2_b32 v[136:137], v21 offset0:192 offset1:193
  v_mfma_f32_16x16x32_bf16 v[216:219], v[68:71], v[116:119], v[216:219]
  ds_read2_b32 v[138:139], v21 offset0:194 offset1:195
  v_mfma_f32_16x16x32_bf16 v[220:223], v[68:71], v[120:123], v[220:223]
  ds_read2_b32 v[140:141], v21 offset0:64 offset1:65
  v_mfma_f32_16x16x32_bf16 v[200:203], v[72:75], v[96:99], v[200:203]
  ds_read2_b32 v[142:143], v21 offset0:66 offset1:67
  v_mfma_f32_16x16x32_bf16 v[204:207], v[72:75], v[100:103], v[204:207]
  ds_read2_b32 v[144:145], v22 offset0:192 offset1:193
  v_mfma_f32_16x16x32_bf16 v[208:211], v[72:75], v[104:107], v[208:211]
  ds_read2_b32 v[146:147], v22 offset0:194 offset1:195
  v_mfma_f32_16x16x32_bf16 v[212:215], v[72:75], v[108:111], v[212:215]
  ds_read2_b32 v[148:149], v22 offset0:64 offset1:65
  v_mfma_f32_16x16x32_bf16 v[216:219], v[72:75], v[112:115], v[216:219]
  ds_read2_b32 v[150:151], v22 offset0:66 offset1:67
  v_mfma_f32_16x16x32_bf16 v[220:223], v[72:75], v[116:119], v[220:223]
  ds_read2_b32 v[152:153], v23 offset0:192 offset1:193
  v_mfma_f32_16x16x32_bf16 v[204:207], v[76:79], v[96:99], v[204:207]
  ds_read2_b32 v[154:155], v23 offset0:194 offset1:195
  v_mfma_f32_16x16x32_bf16 v[208:211], v[76:79], v[100:103], v[208:211]
  ds_read2_b32 v[156:157], v23 offset0:64 offset1:65
  v_mfma_f32_16x16x32_bf16 v[212:215], v[76:79], v[104:107], v[212:215]
  ds_read2_b32 v[158:159], v23 offset0:66 offset1:67
  v_mfma_f32_16x16x32_bf16 v[216:219], v[76:79], v[108:111], v[216:219]
  v_mfma_f32_16x16x32_bf16 v[220:223], v[76:79], v[112:115], v[220:223]
  v_mfma_f32_16x16x32_bf16 v[208:211], v[80:83], v[96:99], v[208:211]
  v_mfma_f32_16x16x32_bf16 v[212:215], v[80:83], v[100:103], v[212:215]
  v_mfma_f32_16x16x32_bf16 v[216:219], v[80:83], v[104:107], v[216:219]
  v_mfma_f32_16x16x32_bf16 v[220:223], v[80:83], v[108:111], v[220:223]
  v_mfma_f32_16x16x32_bf16 v[212:215], v[84:87], v[96:99], v[212:215]
  v_mfma_f32_16x16x32_bf16 v[216:219], v[84:87], v[100:103], v[216:219]
  v_mfma_f32_16x16x32_bf16 v[220:223], v[84:87], v[104:107], v[220:223]
  v_mfma_f32_16x16x32_bf16 v[216:219], v[88:91], v[96:99], v[216:219]
  v_mfma_f32_16x16x32_bf16 v[220:223], v[88:91], v[100:103], v[220:223]
  v_mfma_f32_16x16x32_bf16 v[220:223], v[92:95], v[96:99], v[220:223]
  s_waitcnt lgkmcnt(0)
  v_mfma_f32_16x16x32_bf16 v[192:195], v[128:131], v[160:163], v[192:195]
  ds_read2_b32 v[64:65], v20 offset0:176 offset1:177
  v_mfma_f32_16x16x32_bf16 v[196:199], v[128:131], v[164:167], v[196:199]
  ds_read2_b32 v[66:67], v20 offset0:178 offset1:179
  v_mfma_f32_16x16x32_bf16 v[200:203], v[128:131], v[168:171], v[200:203]
  ds_read_b128 v[96:99], v54 offset:0
  v_mfma_f32_16x16x32_bf16 v[204:207], v[128:131], v[172:175], v[204:207]
  ds_read_b128 v[100:103], v54 offset:1536
  v_mfma_f32_16x16x32_bf16 v[208:211], v[128:131], v[176:179], v[208:211]
  ds_read_b128 v[104:107], v54 offset:3072
  v_mfma_f32_16x16x32_bf16 v[212:215], v[128:131], v[180:183], v[212:215]
  ds_read_b128 v[108:111], v54 offset:4608
  v_mfma_f32_16x16x32_bf16 v[216:219], v[128:131], v[184:187], v[216:219]
  ds_read_b128 v[112:115], v54 offset:6144
  v_mfma_f32_16x16x32_bf16 v[220:223], v[128:131], v[188:191], v[220:223]
  ds_read_b128 v[116:119], v54 offset:7680
  v_mfma_f32_16x16x32_bf16 v[196:199], v[132:135], v[160:163], v[196:199]
  ds_read_b128 v[120:123], v54 offset:9216
  v_mfma_f32_16x16x32_bf16 v[200:203], v[132:135], v[164:167], v[200:203]
  ds_read_b128 v[124:127], v54 offset:10752
  v_mfma_f32_16x16x32_bf16 v[204:207], v[132:135], v[168:171], v[204:207]
  ds_read2_b32 v[68:69], v20 offset0:48 offset1:49
  v_mfma_f32_16x16x32_bf16 v[208:211], v[132:135], v[172:175], v[208:211]
  ds_read2_b32 v[70:71], v20 offset0:50 offset1:51
  v_mfma_f32_16x16x32_bf16 v[212:215], v[132:135], v[176:179], v[212:215]
  ds_read2_b32 v[72:73], v21 offset0:176 offset1:177
  v_mfma_f32_16x16x32_bf16 v[216:219], v[132:135], v[180:183], v[216:219]
  ds_read2_b32 v[74:75], v21 offset0:178 offset1:179
  v_mfma_f32_16x16x32_bf16 v[220:223], v[132:135], v[184:187], v[220:223]
  ds_read2_b32 v[76:77], v21 offset0:48 offset1:49
  v_mfma_f32_16x16x32_bf16 v[200:203], v[136:139], v[160:163], v[200:203]
  ds_read2_b32 v[78:79], v21 offset0:50 offset1:51
  v_mfma_f32_16x16x32_bf16 v[204:207], v[136:139], v[164:167], v[204:207]
  ds_read2_b32 v[80:81], v22 offset0:176 offset1:177
  v_mfma_f32_16x16x32_bf16 v[208:211], v[136:139], v[168:171], v[208:211]
  ds_read2_b32 v[82:83], v22 offset0:178 offset1:179
  v_mfma_f32_16x16x32_bf16 v[212:215], v[136:139], v[172:175], v[212:215]
  ds_read2_b32 v[84:85], v22 offset0:48 offset1:49
  v_mfma_f32_16x16x32_bf16 v[216:219], v[136:139], v[176:179], v[216:219]
  ds_read2_b32 v[86:87], v22 offset0:50 offset1:51
  v_mfma_f32_16x16x32_bf16 v[220:223], v[136:139], v[180:183], v[220:223]
  ds_read2_b32 v[88:89], v23 offset0:176 offset1:177
  v_mfma_f32_16x16x32_bf16 v[204:207], v[140:143], v[160:163], v[204:207]
  ds_read2_b32 v[90:91], v23 offset0:178 offset1:179
  v_mfma_f32_16x16x32_bf16 v[208:211], v[140:143], v[164:167], v[208:211]
  ds_read2_b32 v[92:93], v23 offset0:48 offset1:49
  v_mfma_f32_16x16x32_bf16 v[212:215], v[140:143], v[168:171], v[212:215]
  ds_read2_b32 v[94:95], v23 offset0:50 offset1:51
  v_mfma_f32_16x16x32_bf16 v[216:219], v[140:143], v[172:175], v[216:219]
  v_mfma_f32_16x16x32_bf16 v[220:223], v[140:143], v[176:179], v[220:223]
  v_mfma_f32_16x16x32_bf16 v[208:211], v[144:147], v[160:163], v[208:211]
  v_mfma_f32_16x16x32_bf16 v[212:215], v[144:147], v[164:167], v[212:215]
  v_mfma_f32_16x16x32_bf16 v[216:219], v[144:147], v[168:171], v[216:219]
  v_mfma_f32_16x16x32_bf16 v[220:223], v[144:147], v[172:175], v[220:223]
  v_mfma_f32_16x16x32_bf16 v[212:215], v[148:151], v[160:163], v[212:215]
  v_mfma_f32_16x16x32_bf16 v[216:219], v[148:151], v[164:167], v[216:219]
  v_mfma_f32_16x16x32_bf16 v[220:223], v[148:151], v[168:171], v[220:223]
  v_mfma_f32_16x16x32_bf16 v[216:219], v[152:155], v[160:163], v[216:219]
  v_mfma_f32_16x16x32_bf16 v[220:223], v[152:155], v[164:167], v[220:223]
  v_mfma_f32_16x16x32_bf16 v[220:223], v[156:159], v[160:163], v[220:223]
  s_waitcnt lgkmcnt(0)
  v_mfma_f32_16x16x32_bf16 v[192:195], v[64:67], v[96:99], v[192:195]
  ds_read2_b32 v[128:129], v20 offset0:160 offset1:161
  v_mfma_f32_16x16x32_bf16 v[196:199], v[64:67], v[100:103], v[196:199]
  ds_read2_b32 v[130:131], v20 offset0:162 offset1:163
  v_mfma_f32_16x16x32_bf16 v[200:203], v[64:67], v[104:107], v[200:203]
  ds_read_b128 v[160:163], v55 offset:0
  v_mfma_f32_16x16x32_bf16 v[204:207], v[64:67], v[108:111], v[204:207]
  ds_read_b128 v[164:167], v55 offset:1536
  v_mfma_f32_16x16x32_bf16 v[208:211], v[64:67], v[112:115], v[208:211]
  ds_read_b128 v[168:171], v55 offset:3072
  v_mfma_f32_16x16x32_bf16 v[212:215], v[64:67], v[116:119], v[212:215]
  ds_read_b128 v[172:175], v55 offset:4608
  v_mfma_f32_16x16x32_bf16 v[216:219], v[64:67], v[120:123], v[216:219]
  ds_read_b128 v[176:179], v55 offset:6144
  v_mfma_f32_16x16x32_bf16 v[220:223], v[64:67], v[124:127], v[220:223]
  ds_read_b128 v[180:183], v55 offset:7680
  v_mfma_f32_16x16x32_bf16 v[196:199], v[68:71], v[96:99], v[196:199]
  ds_read_b128 v[184:187], v55 offset:9216
  v_mfma_f32_16x16x32_bf16 v[200:203], v[68:71], v[100:103], v[200:203]
  ds_read_b128 v[188:191], v55 offset:10752
  v_mfma_f32_16x16x32_bf16 v[204:207], v[68:71], v[104:107], v[204:207]
  ds_read2_b32 v[132:133], v20 offset0:32 offset1:33
  v_mfma_f32_16x16x32_bf16 v[208:211], v[68:71], v[108:111], v[208:211]
  ds_read2_b32 v[134:135], v20 offset0:34 offset1:35
  v_mfma_f32_16x16x32_bf16 v[212:215], v[68:71], v[112:115], v[212:215]
  ds_read2_b32 v[136:137], v21 offset0:160 offset1:161
  v_mfma_f32_16x16x32_bf16 v[216:219], v[68:71], v[116:119], v[216:219]
  ds_read2_b32 v[138:139], v21 offset0:162 offset1:163
  v_mfma_f32_16x16x32_bf16 v[220:223], v[68:71], v[120:123], v[220:223]
  ds_read2_b32 v[140:141], v21 offset0:32 offset1:33
  v_mfma_f32_16x16x32_bf16 v[200:203], v[72:75], v[96:99], v[200:203]
  ds_read2_b32 v[142:143], v21 offset0:34 offset1:35
  v_mfma_f32_16x16x32_bf16 v[204:207], v[72:75], v[100:103], v[204:207]
  ds_read2_b32 v[144:145], v22 offset0:160 offset1:161
  v_mfma_f32_16x16x32_bf16 v[208:211], v[72:75], v[104:107], v[208:211]
  ds_read2_b32 v[146:147], v22 offset0:162 offset1:163
  v_mfma_f32_16x16x32_bf16 v[212:215], v[72:75], v[108:111], v[212:215]
  ds_read2_b32 v[148:149], v22 offset0:32 offset1:33
  v_mfma_f32_16x16x32_bf16 v[216:219], v[72:75], v[112:115], v[216:219]
  ds_read2_b32 v[150:151], v22 offset0:34 offset1:35
  v_mfma_f32_16x16x32_bf16 v[220:223], v[72:75], v[116:119], v[220:223]
  ds_read2_b32 v[152:153], v23 offset0:160 offset1:161
  v_mfma_f32_16x16x32_bf16 v[204:207], v[76:79], v[96:99], v[204:207]
  ds_read2_b32 v[154:155], v23 offset0:162 offset1:163
  v_mfma_f32_16x16x32_bf16 v[208:211], v[76:79], v[100:103], v[208:211]
  ds_read2_b32 v[156:157], v23 offset0:32 offset1:33
  v_mfma_f32_16x16x32_bf16 v[212:215], v[76:79], v[104:107], v[212:215]
  ds_read2_b32 v[158:159], v23 offset0:34 offset1:35
  v_mfma_f32_16x16x32_bf16 v[216:219], v[76:79], v[108:111], v[216:219]
  v_mfma_f32_16x16x32_bf16 v[220:223], v[76:79], v[112:115], v[220:223]
  v_mfma_f32_16x16x32_bf16 v[208:211], v[80:83], v[96:99], v[208:211]
  v_mfma_f32_16x16x32_bf16 v[212:215], v[80:83], v[100:103], v[212:215]
  v_mfma_f32_16x16x32_bf16 v[216:219], v[80:83], v[104:107], v[216:219]
  v_mfma_f32_16x16x32_bf16 v[220:223], v[80:83], v[108:111], v[220:223]
  v_mfma_f32_16x16x32_bf16 v[212:215], v[84:87], v[96:99], v[212:215]
  v_mfma_f32_16x16x32_bf16 v[216:219], v[84:87], v[100:103], v[216:219]
  v_mfma_f32_16x16x32_bf16 v[220:223], v[84:87], v[104:107], v[220:223]
  v_mfma_f32_16x16x32_bf16 v[216:219], v[88:91], v[96:99], v[216:219]
  v_mfma_f32_16x16x32_bf16 v[220:223], v[88:91], v[100:103], v[220:223]
  v_mfma_f32_16x16x32_bf16 v[220:223], v[92:95], v[96:99], v[220:223]
  s_waitcnt lgkmcnt(0)
  v_mfma_f32_16x16x32_bf16 v[192:195], v[128:131], v[160:163], v[192:195]
  ds_read2_b32 v[64:65], v20 offset0:144 offset1:145
  v_mfma_f32_16x16x32_bf16 v[196:199], v[128:131], v[164:167], v[196:199]
  ds_read2_b32 v[66:67], v20 offset0:146 offset1:147
  v_mfma_f32_16x16x32_bf16 v[200:203], v[128:131], v[168:171], v[200:203]
  ds_read_b128 v[96:99], v56 offset:0
  v_mfma_f32_16x16x32_bf16 v[204:207], v[128:131], v[172:175], v[204:207]
  ds_read_b128 v[100:103], v56 offset:1536
  v_mfma_f32_16x16x32_bf16 v[208:211], v[128:131], v[176:179], v[208:211]
  ds_read_b128 v[104:107], v56 offset:3072
  v_mfma_f32_16x16x32_bf16 v[212:215], v[128:131], v[180:183], v[212:215]
  ds_read_b128 v[108:111], v56 offset:4608
  v_mfma_f32_16x16x32_bf16 v[216:219], v[128:131], v[184:187], v[216:219]
  ds_read_b128 v[112:115], v56 offset:6144
  v_mfma_f32_16x16x32_bf16 v[220:223], v[128:131], v[188:191], v[220:223]
  ds_read_b128 v[116:119], v56 offset:7680
  v_mfma_f32_16x16x32_bf16 v[196:199], v[132:135], v[160:163], v[196:199]
  ds_read_b128 v[120:123], v56 offset:9216
  v_mfma_f32_16x16x32_bf16 v[200:203], v[132:135], v[164:167], v[200:203]
  ds_read_b128 v[124:127], v56 offset:10752
  v_mfma_f32_16x16x32_bf16 v[204:207], v[132:135], v[168:171], v[204:207]
  ds_read2_b32 v[68:69], v20 offset0:16 offset1:17
  v_mfma_f32_16x16x32_bf16 v[208:211], v[132:135], v[172:175], v[208:211]
  ds_read2_b32 v[70:71], v20 offset0:18 offset1:19
  v_mfma_f32_16x16x32_bf16 v[212:215], v[132:135], v[176:179], v[212:215]
  ds_read2_b32 v[72:73], v21 offset0:144 offset1:145
  v_mfma_f32_16x16x32_bf16 v[216:219], v[132:135], v[180:183], v[216:219]
  ds_read2_b32 v[74:75], v21 offset0:146 offset1:147
  v_mfma_f32_16x16x32_bf16 v[220:223], v[132:135], v[184:187], v[220:223]
  ds_read2_b32 v[76:77], v21 offset0:16 offset1:17
  v_mfma_f32_16x16x32_bf16 v[200:203], v[136:139], v[160:163], v[200:203]
  ds_read2_b32 v[78:79], v21 offset0:18 offset1:19
  v_mfma_f32_16x16x32_bf16 v[204:207], v[136:139], v[164:167], v[204:207]
  ds_read2_b32 v[80:81], v22 offset0:144 offset1:145
  v_mfma_f32_16x16x32_bf16 v[208:211], v[136:139], v[168:171], v[208:211]
  ds_read2_b32 v[82:83], v22 offset0:146 offset1:147
  v_mfma_f32_16x16x32_bf16 v[212:215], v[136:139], v[172:175], v[212:215]
  ds_read2_b32 v[84:85], v22 offset0:16 offset1:17
  v_mfma_f32_16x16x32_bf16 v[216:219], v[136:139], v[176:179], v[216:219]
  ds_read2_b32 v[86:87], v22 offset0:18 offset1:19
  v_mfma_f32_16x16x32_bf16 v[220:223], v[136:139], v[180:183], v[220:223]
  ds_read2_b32 v[88:89], v23 offset0:144 offset1:145
  v_mfma_f32_16x16x32_bf16 v[204:207], v[140:143], v[160:163], v[204:207]
  ds_read2_b32 v[90:91], v23 offset0:146 offset1:147
  v_mfma_f32_16x16x32_bf16 v[208:211], v[140:143], v[164:167], v[208:211]
  ds_read2_b32 v[92:93], v23 offset0:16 offset1:17
  v_mfma_f32_16x16x32_bf16 v[212:215], v[140:143], v[168:171], v[212:215]
  ds_read2_b32 v[94:95], v23 offset0:18 offset1:19
  v_mfma_f32_16x16x32_bf16 v[216:219], v[140:143], v[172:175], v[216:219]
  v_mfma_f32_16x16x32_bf16 v[220:223], v[140:143], v[176:179], v[220:223]
  v_mfma_f32_16x16x32_bf16 v[208:211], v[144:147], v[160:163], v[208:211]
  v_mfma_f32_16x16x32_bf16 v[212:215], v[144:147], v[164:167], v[212:215]
  v_mfma_f32_16x16x32_bf16 v[216:219], v[144:147], v[168:171], v[216:219]
  v_mfma_f32_16x16x32_bf16 v[220:223], v[144:147], v[172:175], v[220:223]
  v_mfma_f32_16x16x32_bf16 v[212:215], v[148:151], v[160:163], v[212:215]
  v_mfma_f32_16x16x32_bf16 v[216:219], v[148:151], v[164:167], v[216:219]
  v_mfma_f32_16x16x32_bf16 v[220:223], v[148:151], v[168:171], v[220:223]
  v_mfma_f32_16x16x32_bf16 v[216:219], v[152:155], v[160:163], v[216:219]
  v_mfma_f32_16x16x32_bf16 v[220:223], v[152:155], v[164:167], v[220:223]
  v_mfma_f32_16x16x32_bf16 v[220:223], v[156:159], v[160:163], v[220:223]
  s_waitcnt lgkmcnt(0)
  v_mfma_f32_16x16x32_bf16 v[192:195], v[64:67], v[96:99], v[192:195]
  ds_read2_b32 v[128:129], v20 offset0:128 offset1:129
  v_mfma_f32_16x16x32_bf16 v[196:199], v[64:67], v[100:103], v[196:199]
  ds_read2_b32 v[130:131], v20 offset0:130 offset1:131
  v_mfma_f32_16x16x32_bf16 v[200:203], v[64:67], v[104:107], v[200:203]
  ds_read_b128 v[160:163], v57 offset:0
  v_mfma_f32_16x16x32_bf16 v[204:207], v[64:67], v[108:111], v[204:207]
  ds_read_b128 v[164:167], v57 offset:1536
  v_mfma_f32_16x16x32_bf16 v[208:211], v[64:67], v[112:115], v[208:211]
  ds_read_b128 v[168:171], v57 offset:3072
  v_mfma_f32_16x16x32_bf16 v[212:215], v[64:67], v[116:119], v[212:215]
  ds_read_b128 v[172:175], v57 offset:4608
  v_mfma_f32_16x16x32_bf16 v[216:219], v[64:67], v[120:123], v[216:219]
  ds_read_b128 v[176:179], v57 offset:6144
  v_mfma_f32_16x16x32_bf16 v[220:223], v[64:67], v[124:127], v[220:223]
  ds_read_b128 v[180:183], v57 offset:7680
  v_mfma_f32_16x16x32_bf16 v[196:199], v[68:71], v[96:99], v[196:199]
  ds_read_b128 v[184:187], v57 offset:9216
  v_mfma_f32_16x16x32_bf16 v[200:203], v[68:71], v[100:103], v[200:203]
  ds_read_b128 v[188:191], v57 offset:10752
  v_mfma_f32_16x16x32_bf16 v[204:207], v[68:71], v[104:107], v[204:207]
  ds_read2_b32 v[132:133], v20 offset0:0 offset1:1
  v_mfma_f32_16x16x32_bf16 v[208:211], v[68:71], v[108:111], v[208:211]
  ds_read2_b32 v[134:135], v20 offset0:2 offset1:3
  v_mfma_f32_16x16x32_bf16 v[212:215], v[68:71], v[112:115], v[212:215]
  ds_read2_b32 v[136:137], v21 offset0:128 offset1:129
  v_mfma_f32_16x16x32_bf16 v[216:219], v[68:71], v[116:119], v[216:219]
  ds_read2_b32 v[138:139], v21 offset0:130 offset1:131
  v_mfma_f32_16x16x32_bf16 v[220:223], v[68:71], v[120:123], v[220:223]
  ds_read2_b32 v[140:141], v21 offset0:0 offset1:1
  v_mfma_f32_16x16x32_bf16 v[200:203], v[72:75], v[96:99], v[200:203]
  ds_read2_b32 v[142:143], v21 offset0:2 offset1:3
  v_mfma_f32_16x16x32_bf16 v[204:207], v[72:75], v[100:103], v[204:207]
  ds_read2_b32 v[144:145], v22 offset0:128 offset1:129
  v_mfma_f32_16x16x32_bf16 v[208:211], v[72:75], v[104:107], v[208:211]
  ds_read2_b32 v[146:147], v22 offset0:130 offset1:131
  v_mfma_f32_16x16x32_bf16 v[212:215], v[72:75], v[108:111], v[212:215]
  ds_read2_b32 v[148:149], v22 offset0:0 offset1:1
  v_mfma_f32_16x16x32_bf16 v[216:219], v[72:75], v[112:115], v[216:219]
  ds_read2_b32 v[150:151], v22 offset0:2 offset1:3
  v_mfma_f32_16x16x32_bf16 v[220:223], v[72:75], v[116:119], v[220:223]
  ds_read2_b32 v[152:153], v23 offset0:128 offset1:129
  v_mfma_f32_16x16x32_bf16 v[204:207], v[76:79], v[96:99], v[204:207]
  ds_read2_b32 v[154:155], v23 offset0:130 offset1:131
  v_mfma_f32_16x16x32_bf16 v[208:211], v[76:79], v[100:103], v[208:211]
  ds_read2_b32 v[156:157], v23 offset0:0 offset1:1
  v_mfma_f32_16x16x32_bf16 v[212:215], v[76:79], v[104:107], v[212:215]
  ds_read2_b32 v[158:159], v23 offset0:2 offset1:3
  v_mfma_f32_16x16x32_bf16 v[216:219], v[76:79], v[108:111], v[216:219]
  v_mfma_f32_16x16x32_bf16 v[220:223], v[76:79], v[112:115], v[220:223]
  v_mfma_f32_16x16x32_bf16 v[208:211], v[80:83], v[96:99], v[208:211]
  v_mfma_f32_16x16x32_bf16 v[212:215], v[80:83], v[100:103], v[212:215]
  v_mfma_f32_16x16x32_bf16 v[216:219], v[80:83], v[104:107], v[216:219]
  v_mfma_f32_16x16x32_bf16 v[220:223], v[80:83], v[108:111], v[220:223]
  v_mfma_f32_16x16x32_bf16 v[212:215], v[84:87], v[96:99], v[212:215]
  v_mfma_f32_16x16x32_bf16 v[216:219], v[84:87], v[100:103], v[216:219]
  v_mfma_f32_16x16x32_bf16 v[220:223], v[84:87], v[104:107], v[220:223]
  v_mfma_f32_16x16x32_bf16 v[216:219], v[88:91], v[96:99], v[216:219]
  v_mfma_f32_16x16x32_bf16 v[220:223], v[88:91], v[100:103], v[220:223]
  v_mfma_f32_16x16x32_bf16 v[220:223], v[92:95], v[96:99], v[220:223]
  s_waitcnt lgkmcnt(0)
  v_mfma_f32_16x16x32_bf16 v[192:195], v[128:131], v[160:163], v[192:195]
  v_mfma_f32_16x16x32_bf16 v[196:199], v[128:131], v[164:167], v[196:199]
  v_mfma_f32_16x16x32_bf16 v[200:203], v[128:131], v[168:171], v[200:203]
  v_mfma_f32_16x16x32_bf16 v[204:207], v[128:131], v[172:175], v[204:207]
  v_mfma_f32_16x16x32_bf16 v[208:211], v[128:131], v[176:179], v[208:211]
  v_mfma_f32_16x16x32_bf16 v[212:215], v[128:131], v[180:183], v[212:215]
  v_mfma_f32_16x16x32_bf16 v[216:219], v[128:131], v[184:187], v[216:219]
  v_mfma_f32_16x16x32_bf16 v[220:223], v[128:131], v[188:191], v[220:223]
  v_mfma_f32_16x16x32_bf16 v[196:199], v[132:135], v[160:163], v[196:199]
  v_mfma_f32_16x16x32_bf16 v[200:203], v[132:135], v[164:167], v[200:203]
  v_mfma_f32_16x16x32_bf16 v[204:207], v[132:135], v[168:171], v[204:207]
  v_mfma_f32_16x16x32_bf16 v[208:211], v[132:135], v[172:175], v[208:211]
  v_mfma_f32_16x16x32_bf16 v[212:215], v[132:135], v[176:179], v[212:215]
  v_mfma_f32_16x16x32_bf16 v[216:219], v[132:135], v[180:183], v[216:219]
  v_mfma_f32_16x16x32_bf16 v[220:223], v[132:135], v[184:187], v[220:223]
  v_mfma_f32_16x16x32_bf16 v[200:203], v[136:139], v[160:163], v[200:203]
  v_mfma_f32_16x16x32_bf16 v[204:207], v[136:139], v[164:167], v[204:207]
  v_mfma_f32_16x16x32_bf16 v[208:211], v[136:139], v[168:171], v[208:211]
  v_mfma_f32_16x16x32_bf16 v[212:215], v[136:139], v[172:175], v[212:215]
  v_mfma_f32_16x16x32_bf16 v[216:219], v[136:139], v[176:179], v[216:219]
  v_mfma_f32_16x16x32_bf16 v[220:223], v[136:139], v[180:183], v[220:223]
  v_mfma_f32_16x16x32_bf16 v[204:207], v[140:143], v[160:163], v[204:207]
  v_mfma_f32_16x16x32_bf16 v[208:211], v[140:143], v[164:167], v[208:211]
  v_mfma_f32_16x16x32_bf16 v[212:215], v[140:143], v[168:171], v[212:215]
  v_mfma_f32_16x16x32_bf16 v[216:219], v[140:143], v[172:175], v[216:219]
  v_mfma_f32_16x16x32_bf16 v[220:223], v[140:143], v[176:179], v[220:223]
  v_mfma_f32_16x16x32_bf16 v[208:211], v[144:147], v[160:163], v[208:211]
  v_mfma_f32_16x16x32_bf16 v[212:215], v[144:147], v[164:167], v[212:215]
  v_mfma_f32_16x16x32_bf16 v[216:219], v[144:147], v[168:171], v[216:219]
  v_mfma_f32_16x16x32_bf16 v[220:223], v[144:147], v[172:175], v[220:223]
  v_mfma_f32_16x16x32_bf16 v[212:215], v[148:151], v[160:163], v[212:215]
  v_mfma_f32_16x16x32_bf16 v[216:219], v[148:151], v[164:167], v[216:219]
  v_mfma_f32_16x16x32_bf16 v[220:223], v[148:151], v[168:171], v[220:223]
  v_mfma_f32_16x16x32_bf16 v[216:219], v[152:155], v[160:163], v[216:219]
  v_mfma_f32_16x16x32_bf16 v[220:223], v[152:155], v[164:167], v[220:223]
  v_mfma_f32_16x16x32_bf16 v[220:223], v[156:159], v[160:163], v[220:223]
  v_cvt_pk_bf16_f32 v64, v192, v193
  v_cvt_pk_bf16_f32 v65, v194, v195
  buffer_store_dwordx2 v[64:65], v25, s[24:27], s39 offen offset:0 sc1
  v_cvt_pk_bf16_f32 v66, v196, v197
  v_cvt_pk_bf16_f32 v67, v198, v199
  buffer_store_dwordx2 v[66:67], v25, s[24:27], s39 offen offset:512 sc1
  v_cvt_pk_bf16_f32 v68, v200, v201
  v_cvt_pk_bf16_f32 v69, v202, v203
  buffer_store_dwordx2 v[68:69], v25, s[24:27], s39 offen offset:1024 sc1
  v_cvt_pk_bf16_f32 v70, v204, v205
  v_cvt_pk_bf16_f32 v71, v206, v207
  buffer_store_dwordx2 v[70:71], v25, s[24:27], s39 offen offset:1536 sc1
  v_cvt_pk_bf16_f32 v72, v208, v209
  v_cvt_pk_bf16_f32 v73, v210, v211
  buffer_store_dwordx2 v[72:73], v25, s[24:27], s39 offen offset:2048 sc1
  v_cvt_pk_bf16_f32 v74, v212, v213
  v_cvt_pk_bf16_f32 v75, v214, v215
  buffer_store_dwordx2 v[74:75], v25, s[24:27], s39 offen offset:2560 sc1
  v_cvt_pk_bf16_f32 v76, v216, v217
  v_cvt_pk_bf16_f32 v77, v218, v219
  buffer_store_dwordx2 v[76:77], v25, s[24:27], s39 offen offset:3072 sc1
  v_cvt_pk_bf16_f32 v78, v220, v221
  v_cvt_pk_bf16_f32 v79, v222, v223
  buffer_store_dwordx2 v[78:79], v25, s[24:27], s39 offen offset:3584 sc1
  v_add_u32 v50, 256, v50
  v_add_u32 v51, 256, v51
  v_add_u32 v52, 256, v52
  v_add_u32 v53, 256, v53
  v_add_u32 v54, 256, v54
  v_add_u32 v55, 256, v55
  v_add_u32 v56, 256, v56
  v_add_u32 v57, 256, v57
  s_add_u32 s38, s38, 1
  s_cmp_lt_u32 s38, s30
  s_cbranch_scc1 L_cv_round
  s_waitcnt vmcnt(0)
  s_lshl_b32 s36, s29, 8
  s_add_u32 s36, s36, 7168
  v_mov_b32 v4, 1
  v_mov_b32 v5, 0
  s_mov_b64 exec, 1
  buffer_atomic_add v4, v5, s[8:11], s36 offen sc1
  s_endpgm
L_m_w4:
  s_load_dwordx2 s[48:49], s[0:1], 96
  s_load_dwordx8 s[80:87], s[0:1], 8
  s_load_dwordx4 s[52:55], s[0:1], 40
  s_load_dwordx2 s[56:57], s[0:1], 72
  s_load_dwordx2 s[58:59], s[0:1], 88
  s_waitcnt lgkmcnt(0)
  s_add_u32 s36, s4, 0x0
  s_addc_u32 s37, s5, 0
  s_mov_b32 s38, 0x40000
  s_mov_b32 s39, 0x20000
  s_add_u32 s26, s4, 0xff00
  s_addc_u32 s27, s5, 0
  s_load_dword s101, s[26:27], 0
  s_mov_b32 s8, s4
  s_mov_b32 s9, s5
  s_mov_b32 s10, 0x4c0000
  s_mov_b32 s11, 0x20000
  s_mov_b32 s16, s96
  s_mov_b32 s17, s97
  s_mov_b32 s18, 0x500000
  s_mov_b32 s19, 0x20000
  v_lshlrev_b32 v4, 21, v1
  buffer_load_dword v100, v4, s[8:11], 0 offen sc1
  buffer_load_dword v104, v4, s[16:19], 0 offen
  s_mov_b32 s8, s56
  s_mov_b32 s9, s57
  s_mov_b32 s10, 0x4
  s_mov_b32 s11, 0x20000
  buffer_load_dword v105, v4, s[8:11], 0 offen
  s_cmp_lg_u32 s2, 0
  s_cbranch_scc1 L_m_nt0
  v_mul_u32_u24 v5, 256, v1
  s_mov_b32 s23, 65536
  buffer_load_dword v103, v5, s[36:39], s23 offen
L_m_nt0:
  s_cmp_lg_u32 s2, 5
  s_cbranch_scc1 L_m_nt1
  v_mul_u32_u24 v5, 256, v1
  s_mov_b32 s23, 196608
  buffer_load_dword v103, v5, s[36:39], s23 offen
L_m_nt1:
  s_cmp_lg_u32 s2, 6
  s_cbranch_scc1 L_m_nt2
  v_mul_u32_u24 v5, 256, v1
  s_mov_b32 s23, 7168
  v_min_u32 v5, 1280, v5
  buffer_load_dword v103, v5, s[36:39], s23 offen
L_m_nt2:
  s_sub_u32 s23, s2, 1
  s_cmp_ge_u32 s23, 4
  s_cbranch_scc1 L_m_notouch2
  v_lshlrev_b32 v5, 8, v1
  s_lshl_b32 s23, s23, 14
  s_add_u32 s23, s23, 131072
  buffer_load_dword v103, v5, s[36:39], s23 offen
L_m_notouch2:
  s_mov_b32 s32, s96
  s_mov_b32 s33, s97
  s_mov_b32 s34, 0x1200000
  s_mov_b32 s35, 0x20000
  s_lshr_b32 s30, s2, 3
  v_and_b32 v1, 63, v0
  v_lshrrev_b32 v30, 4, v1
  v_mul_u32_u24 v30, 9216, v30
  v_and_b32 v31, 15, v1
  v_lshl_add_u32 v30, v31, 4, v30
  s_and_b32 s42, s2, 1
  s_and_b32 s40, s2, 7
  s_mul_i32 s40, s40, 9
  s_add_u32 s40, s40, 1
  s_lshr_b32 s40, s40, 1
  s_lshl_b32 s40, s40, 8
  s_mul_i32 s41, s30, 36864
  s_add_u32 s40, s40, s41
  s_add_u32 s40, s40, 0
  s_mul_i32 s43, s42, 1280
  s_sub_u32 s43, 1024, s43
  s_add_u32 s42, s42, s30
  s_mov_b32 s44, 3
L_m0_pw1:
  buffer_load_dwordx4 v[64:67], v30, s[32:35], s40 offen offset:0
  buffer_load_dwordx4 v[68:71], v30, s[32:35], s40 offen offset:256
  buffer_load_dwordx4 v[72:75], v30, s[32:35], s40 offen offset:512
  buffer_load_dwordx4 v[76:79], v30, s[32:35], s40 offen offset:768
  s_add_u32 s41, s40, s43
  buffer_load_dwordx4 v[80:83], v30, s[32:35], s41 offen
L_m0_sk1:
  s_add_u32 s42, s42, 33
  s_add_u32 s40, s40, 1179648
  s_waitcnt vmcnt(12)
  s_sub_u32 s44, s44, 1
  s_cmp_lg_u32 s44, 0
  s_cbranch_scc1 L_m0_pw1
  s_waitcnt lgkmcnt(0)
  s_mul_i32 s101, s101, 0x9e3779b1
  s_add_u32 s101, s101, 0x7f4a7c15
  s_andn2_b32 s100, s101, 0xff
  s_barrier
  s_cmp_ge_u32 s2, 216
  s_cbranch_scc1 L_m_helper
  s_and_b32 s12, s2, 7
  s_lshr_b32 s13, s2, 3
  s_and_b32 s14, s12, 1
  s_mul_i32 s14, s14, 3
  s_add_u32 s13, s13, s14
  s_cmp_ge_u32 s13, 27
  s_cselect_b32 s14, 27, 0
  s_sub_u32 s13, s13, s14
  s_mul_i32 s12, s12, 27
  s_add_u32 s12, s12, s13
  s_mul_i32 s14, s12, 10923
  s_lshr_b32 s14, s14, 16
  s_mul_i32 s15, s14, 6
  s_sub_u32 s15, s12, s15
  v_and_b32 v1, 63, v0
  v_and_b32 v2, 15, v1
  v_lshrrev_b32 v3, 4, v1
  v_lshlrev_b32 v7, 4, v1
  s_mul_i32 s21, s15, 12288
  s_lshl_b32 s22, s14, 8
  v_mul_u32_u24 v4, 9216, v3
  v_lshlrev_b32 v5, 1, v3
  v_xor_b32 v5, v5, v2
  v_lshl_add_u32 v6, v5, 4, v4
  v_xor_b32 v5, 8, v5
  v_lshl_add_u32 v8, v5, 4, v4
  v_add_u32 v40, 0, v6
  v_add_u32 v41, 35840, v6
  v_add_u32 v42, 71680, v8
  v_add_u32 v43, 107520, v8
  s_add_u32 s28, s4, 0x40000
  s_addc_u32 s29, s5, 0
  s_mov_b32 s30, 0x240000
  s_mov_b32 s31, 0x20000
  s_lshr_b32 s60, s2, 3
  s_mul_i32 s60, s60, 10923
  s_lshr_b32 s60, s60, 16
  v_mov_b32 v58, 158724
L_lw1:
  s_sleep 2
  ds_read_b32 v60, v58
  s_waitcnt lgkmcnt(0)
  v_readfirstlane_b32 s23, v60
  s_nop 0
  s_cmp_lt_u32 s23, 4
  s_cbranch_scc1 L_lw1
  s_mov_b32 m0, 0
  s_nop 0
  buffer_load_dwordx4 v40, s[32:35], s22 offen offset:0 lds
  buffer_load_dwordx4 v41, s[32:35], s22 offen offset:1024 lds
  buffer_load_dwordx4 v42, s[32:35], s22 offen offset:2048 lds
  buffer_load_dwordx4 v43, s[32:35], s22 offen offset:3072 lds
  s_add_u32 s22, s22, 147456
  s_mov_b32 m0, 4096
  s_nop 0
  buffer_load_dwordx4 v40, s[32:35], s22 offen offset:0 lds
  buffer_load_dwordx4 v41, s[32:35], s22 offen offset:1024 lds
  buffer_load_dwordx4 v42, s[32:35], s22 offen offset:2048 lds
  buffer_load_dwordx4 v43, s[32:35], s22 offen offset:3072 lds
  s_add_u32 s22, s22, 147456
  s_mov_b32 m0, 8192
  s_nop 0
  buffer_load_dwordx4 v40, s[32:35], s22 offen offset:0 lds
  buffer_load_dwordx4 v41, s[32:35], s22 offen offset:1024 lds
  buffer_load_dwordx4 v42, s[32:35], s22 offen offset:2048 lds
  buffer_load_dwordx4 v43, s[32:35], s22 offen offset:3072 lds
  s_add_u32 s22, s22, 147456
  s_mov_b32 m0, 12288
  s_nop 0
  buffer_load_dwordx4 v40, s[32:35], s22 offen offset:0 lds
  buffer_load_dwordx4 v41, s[32:35], s22 offen offset:1024 lds
  buffer_load_dwordx4 v42, s[32:35], s22 offen offset:2048 lds
  buffer_load_dwordx4 v43, s[32:35], s22 offen offset:3072 lds
  s_add_u32 s22, s22, 147456
  s_mov_b32 m0, 28672
  s_nop 0
  buffer_load_dwordx4 v40, s[32:35], s22 offen offset:0 lds
  buffer_load_dwordx4 v41, s[32:35], s22 offen offset:1024 lds
  buffer_load_dwordx4 v42, s[32:35], s22 offen offset:2048 lds
  buffer_load_dwordx4 v43, s[32:35], s22 offen offset:3072 lds
  s_add_u32 s22, s22, 147456
  s_mov_b32 m0, 32768
  s_nop 0
  buffer_load_dwordx4 v40, s[32:35], s22 offen offset:0 lds
  buffer_load_dwordx4 v41, s[32:35], s22 offen offset:1024 lds
  buffer_load_dwordx4 v42, s[32:35], s22 offen offset:2048 lds
  buffer_load_dwordx4 v43, s[32:35], s22 offen offset:3072 lds
  s_add_u32 s22, s22, 147456
  s_mov_b32 m0, 36864
  s_nop 0
  buffer_load_dwordx4 v40, s[32:35], s22 offen offset:0 lds
  buffer_load_dwordx4 v41, s[32:35], s22 offen offset:1024 lds
  buffer_load_dwordx4 v42, s[32:35], s22 offen offset:2048 lds
  buffer_load_dwordx4 v43, s[32:35], s22 offen offset:3072 lds
  s_add_u32 s22, s22, 147456
  s_mov_b32 m0, 40960
  s_nop 0
  buffer_load_dwordx4 v40, s[32:35], s22 offen offset:0 lds
  buffer_load_dwordx4 v41, s[32:35], s22 offen offset:1024 lds
  buffer_load_dwordx4 v42, s[32:35], s22 offen offset:2048 lds
  buffer_load_dwordx4 v43, s[32:35], s22 offen offset:3072 lds
  s_add_u32 s22, s22, 147456
  s_mov_b32 m0, 57344
  s_nop 0
  buffer_load_dwordx4 v40, s[32:35], s22 offen offset:0 lds
  buffer_load_dwordx4 v41, s[32:35], s22 offen offset:1024 lds
  buffer_load_dwordx4 v42, s[32:35], s22 offen offset:2048 lds
  buffer_load_dwordx4 v43, s[32:35], s22 offen offset:3072 lds
  s_add_u32 s22, s22, 147456
  s_mov_b32 m0, 61440
  s_nop 0
  buffer_load_dwordx4 v40, s[32:35], s22 offen offset:0 lds
  buffer_load_dwordx4 v41, s[32:35], s22 offen offset:1024 lds
  buffer_load_dwordx4 v42, s[32:35], s22 offen offset:2048 lds
  buffer_load_dwordx4 v43, s[32:35], s22 offen offset:3072 lds
  s_add_u32 s22, s22, 147456
  s_mov_b32 m0, 65536
  s_nop 0
  buffer_load_dwordx4 v40, s[32:35], s22 offen offset:0 lds
  buffer_load_dwordx4 v41, s[32:35], s22 offen offset:1024 lds
  buffer_load_dwordx4 v42, s[32:35], s22 offen offset:2048 lds
  buffer_load_dwordx4 v43, s[32:35], s22 offen offset:3072 lds
  s_add_u32 s22, s22, 147456
  s_mov_b32 m0, 69632
  s_nop 0
  buffer_load_dwordx4 v40, s[32:35], s22 offen offset:0 lds
  buffer_load_dwordx4 v41, s[32:35], s22 offen offset:1024 lds
  buffer_load_dwordx4 v42, s[32:35], s22 offen offset:2048 lds
  buffer_load_dwordx4 v43, s[32:35], s22 offen offset:3072 lds
  s_add_u32 s22, s22, 147456
  s_mov_b32 m0, 86016
  s_nop 0
  buffer_load_dwordx4 v40, s[32:35], s22 offen offset:0 lds
  buffer_load_dwordx4 v41, s[32:35], s22 offen offset:1024 lds
  buffer_load_dwordx4 v42, s[32:35], s22 offen offset:2048 lds
  buffer_load_dwordx4 v43, s[32:35], s22 offen offset:3072 lds
  s_add_u32 s22, s22, 147456
  s_mov_b32 m0, 90112
  s_nop 0
  buffer_load_dwordx4 v40, s[32:35], s22 offen offset:0 lds
  buffer_load_dwordx4 v41, s[32:35], s22 offen offset:1024 lds
  buffer_load_dwordx4 v42, s[32:35], s22 offen offset:2048 lds
  buffer_load_dwordx4 v43, s[32:35], s22 offen offset:3072 lds
  s_add_u32 s22, s22, 147456
  s_mov_b32 m0, 94208
  s_nop 0
  buffer_load_dwordx4 v40, s[32:35], s22 offen offset:0 lds
  buffer_load_dwordx4 v41, s[32:35], s22 offen offset:1024 lds
  buffer_load_dwordx4 v42, s[32:35], s22 offen offset:2048 lds
  buffer_load_dwordx4 v43, s[32:35], s22 offen offset:3072 lds
  s_add_u32 s22, s22, 147456
  s_mov_b32 m0, 98304
  s_nop 0
  buffer_load_dwordx4 v40, s[32:35], s22 offen offset:0 lds
  buffer_load_dwordx4 v41, s[32:35], s22 offen offset:1024 lds
  buffer_load_dwordx4 v42, s[32:35], s22 offen offset:2048 lds
  buffer_load_dwordx4 v43, s[32:35], s22 offen offset:3072 lds
  s_add_u32 s22, s22, 147456
  v_mul_u32_u24 v61, 256, v1
  s_mov_b32 s61, 0x100000
L_l1_poll:
  s_mov_b32 s62, 65536
  buffer_load_dwordx4 v[180:183], v61, s[36:39], s62 offen sc1
  s_sub_u32 s61, s61, 1
  s_cbranch_scc1 L_l1_go
  s_waitcnt vmcnt(0)
  v_xor_b32 v180, s101, v180
  v_xor_b32 v181, s101, v181
  v_xor_b32 v182, s101, v182
  v_xor_b32 v183, s101, v183
  v_or3_b32 v180, v180, v181, v182
  v_or_b32 v180, v180, v183
  v_cmp_ne_u32 vcc, 0, v180
  s_nop 0
  s_cmp_eq_u64 vcc, 0
  s_cbranch_scc1 L_l1_go
  s_sleep 4
  s_branch L_l1_poll
L_l1_go:
  s_cmp_lg_u32 s2, 0
  s_cbranch_scc1 L_m_noseed
  v_mov_b32 v4, s101
  v_mov_b32 v5, 65280
  s_mov_b64 exec, 1
  buffer_store_dword v4, v5, s[36:39], 0 offen sc1
  s_mov_b64 exec, -1
L_m_noseed:
  s_mov_b32 m0, 16384
  s_nop 0
  buffer_load_dwordx4 v7, s[28:31], s21 offen offset:0 sc1 lds
  buffer_load_dwordx4 v7, s[28:31], s21 offen offset:1024 sc1 lds
  buffer_load_dwordx4 v7, s[28:31], s21 offen offset:2048 sc1 lds
  buffer_load_dwordx4 v7, s[28:31], s21 offen offset:3072 sc1 lds
  s_add_u32 s21, s21, 4096
  s_mov_b32 m0, 20480
  s_nop 0
  buffer_load_dwordx4 v7, s[28:31], s21 offen offset:0 sc1 lds
  buffer_load_dwordx4 v7, s[28:31], s21 offen offset:1024 sc1 lds
  buffer_load_dwordx4 v7, s[28:31], s21 offen offset:2048 sc1 lds
  buffer_load_dwordx4 v7, s[28:31], s21 offen offset:3072 sc1 lds
  s_add_u32 s21, s21, 4096
  s_mov_b32 m0, 24576
  s_nop 0
  buffer_load_dwordx4 v7, s[28:31], s21 offen offset:0 sc1 lds
  buffer_load_dwordx4 v7, s[28:31], s21 offen offset:1024 sc1 lds
  buffer_load_dwordx4 v7, s[28:31], s21 offen offset:2048 sc1 lds
  buffer_load_dwordx4 v7, s[28:31], s21 offen offset:3072 sc1 lds
  s_add_u32 s21, s21, 65536
  s_mov_b32 m0, 45056
  s_nop 0
  buffer_load_dwordx4 v7, s[28:31], s21 offen offset:0 sc1 lds
  buffer_load_dwordx4 v7, s[28:31], s21 offen offset:1024 sc1 lds
  buffer_load_dwordx4 v7, s[28:31], s21 offen offset:2048 sc1 lds
  buffer_load_dwordx4 v7, s[28:31], s21 offen offset:3072 sc1 lds
  s_add_u32 s21, s21, 4096
  s_mov_b32 m0, 49152
  s_nop 0
  buffer_load_dwordx4 v7, s[28:31], s21 offen offset:0 sc1 lds
  buffer_load_dwordx4 v7, s[28:31], s21 offen offset:1024 sc1 lds
  buffer_load_dwordx4 v7, s[28:31], s21 offen offset:2048 sc1 lds
  buffer_load_dwordx4 v7, s[28:31], s21 offen offset:3072 sc1 lds
  s_add_u32 s21, s21, 4096
  s_mov_b32 m0, 53248
  s_nop 0
  buffer_load_dwordx4 v7, s[28:31], s21 offen offset:0 sc1 lds
  buffer_load_dwordx4 v7, s[28:31], s21 offen offset:1024 sc1 lds
  buffer_load_dwordx4 v7, s[28:31], s21 offen offset:2048 sc1 lds
  buffer_load_dwordx4 v7, s[28:31], s21 offen offset:3072 sc1 lds
  s_add_u32 s21, s21, 65536
  s_mov_b32 m0, 73728
  s_nop 0
  buffer_load_dwordx4 v7, s[28:31], s21 offen offset:0 sc1 lds
  buffer_load_dwordx4 v7, s[28:31], s21 offen offset:1024 sc1 lds
  buffer_load_dwordx4 v7, s[28:31], s21 offen offset:2048 sc1 lds
  buffer_load_dwordx4 v7, s[28:31], s21 offen offset:3072 sc1 lds
  s_add_u32 s21, s21, 4096
  s_mov_b32 m0, 77824
  s_nop 0
  buffer_load_dwordx4 v7, s[28:31], s21 offen offset:0 sc1 lds
  buffer_load_dwordx4 v7, s[28:31], s21 offen offset:1024 sc1 lds
  buffer_load_dwordx4 v7, s[28:31], s21 offen offset:2048 sc1 lds
  buffer_load_dwordx4 v7, s[28:31], s21 offen offset:3072 sc1 lds
  s_add_u32 s21, s21, 4096
  s_mov_b32 m0, 81920
  s_nop 0
  buffer_load_dwordx4 v7, s[28:31], s21 offen offset:0 sc1 lds
  buffer_load_dwordx4 v7, s[28:31], s21 offen offset:1024 sc1 lds
  buffer_load_dwordx4 v7, s[28:31], s21 offen offset:2048 sc1 lds
  buffer_load_dwordx4 v7, s[28:31], s21 offen offset:3072 sc1 lds
  s_add_u32 s21, s21, 65536
  s_mov_b32 m0, 102400
  s_nop 0
  buffer_load_dwordx4 v7, s[28:31], s21 offen offset:0 sc1 lds
  buffer_load_dwordx4 v7, s[28:31], s21 offen offset:1024 sc1 lds
  buffer_load_dwordx4 v7, s[28:31], s21 offen offset:2048 sc1 lds
  buffer_load_dwordx4 v7, s[28:31], s21 offen offset:3072 sc1 lds
  s_add_u32 s21, s21, 4096
  s_mov_b32 m0, 106496
  s_nop 0
  buffer_load_dwordx4 v7, s[28:31], s21 offen offset:0 sc1 lds
  buffer_load_dwordx4 v7, s[28:31], s21 offen offset:1024 sc1 lds
  buffer_load_dwordx4 v7, s[28:31], s21 offen offset:2048 sc1 lds
  buffer_load_dwordx4 v7, s[28:31], s21 offen offset:3072 sc1 lds
  s_add_u32 s21, s21, 4096
  s_mov_b32 m0, 110592
  s_nop 0
  buffer_load_dwordx4 v7, s[28:31], s21 offen offset:0 sc1 lds
  buffer_load_dwordx4 v7, s[28:31], s21 offen offset:1024 sc1 lds
  buffer_load_dwordx4 v7, s[28:31], s21 offen offset:2048 sc1 lds
  buffer_load_dwordx4 v7, s[28:31], s21 offen offset:3072 sc1 lds
  s_add_u32 s21, s21, 65536
  s_waitcnt vmcnt(36)
  s_barrier
  s_waitcnt vmcnt(24)
  s_barrier
  s_mov_b32 s25, 7
L_g1_lloop:
  s_mov_b32 m0, 16384
  s_nop 0
  buffer_load_dwordx4 v7, s[28:31], s21 offen offset:0 sc1 lds
  buffer_load_dwordx4 v7, s[28:31], s21 offen offset:1024 sc1 lds
  buffer_load_dwordx4 v7, s[28:31], s21 offen offset:2048 sc1 lds
  buffer_load_dwordx4 v7, s[28:31], s21 offen offset:3072 sc1 lds
  s_add_u32 s21, s21, 4096
  s_mov_b32 m0, 0
  s_nop 0
  buffer_load_dwordx4 v40, s[32:35], s22 offen offset:0 lds
  buffer_load_dwordx4 v41, s[32:35], s22 offen offset:1024 lds
  buffer_load_dwordx4 v42, s[32:35], s22 offen offset:2048 lds
  buffer_load_dwordx4 v43, s[32:35], s22 offen offset:3072 lds
  s_add_u32 s22, s22, 147456
  s_mov_b32 m0, 4096
  s_nop 0
  buffer_load_dwordx4 v40, s[32:35], s22 offen offset:0 lds
  buffer_load_dwordx4 v41, s[32:35], s22 offen offset:1024 lds
  buffer_load_dwordx4 v42, s[32:35], s22 offen offset:2048 lds
  buffer_load_dwordx4 v43, s[32:35], s22 offen offset:3072 lds
  s_add_u32 s22, s22, 147456
  s_mov_b32 m0, 20480
  s_nop 0
  buffer_load_dwordx4 v7, s[28:31], s21 offen offset:0 sc1 lds
  buffer_load_dwordx4 v7, s[28:31], s21 offen offset:1024 sc1 lds
  buffer_load_dwordx4 v7, s[28:31], s21 offen offset:2048 sc1 lds
  buffer_load_dwordx4 v7, s[28:31], s21 offen offset:3072 sc1 lds
  s_add_u32 s21, s21, 4096
  s_mov_b32 m0, 8192
  s_nop 0
  buffer_load_dwordx4 v40, s[32:35], s22 offen offset:0 lds
  buffer_load_dwordx4 v41, s[32:35], s22 offen offset:1024 lds
  buffer_load_dwordx4 v42, s[32:35], s22 offen offset:2048 lds
  buffer_load_dwordx4 v43, s[32:35], s22 offen offset:3072 lds
  s_add_u32 s22, s22, 147456
  s_mov_b32 m0, 24576
  s_nop 0
  buffer_load_dwordx4 v7, s[28:31], s21 offen offset:0 sc1 lds
  buffer_load_dwordx4 v7, s[28:31], s21 offen offset:1024 sc1 lds
  buffer_load_dwordx4 v7, s[28:31], s21 offen offset:2048 sc1 lds
  buffer_load_dwordx4 v7, s[28:31], s21 offen offset:3072 sc1 lds
  s_add_u32 s21, s21, 65536
  s_mov_b32 m0, 12288
  s_nop 0
  buffer_load_dwordx4 v40, s[32:35], s22 offen offset:0 lds
  buffer_load_dwordx4 v41, s[32:35], s22 offen offset:1024 lds
  buffer_load_dwordx4 v42, s[32:35], s22 offen offset:2048 lds
  buffer_load_dwordx4 v43, s[32:35], s22 offen offset:3072 lds
  s_add_u32 s22, s22, 147456
  s_cmp_lg_u32 s25, 7
  s_cbranch_scc1 L_g1_steady
  s_waitcnt vmcnt(40)
L_g1_steady:
  s_waitcnt vmcnt(56)
  s_barrier
  s_mov_b32 m0, 45056
  s_nop 0
  buffer_load_dwordx4 v7, s[28:31], s21 offen offset:0 sc1 lds
  buffer_load_dwordx4 v7, s[28:31], s21 offen offset:1024 sc1 lds
  buffer_load_dwordx4 v7, s[28:31], s21 offen offset:2048 sc1 lds
  buffer_load_dwordx4 v7, s[28:31], s21 offen offset:3072 sc1 lds
  s_add_u32 s21, s21, 4096
  s_mov_b32 m0, 28672
  s_nop 0
  buffer_load_dwordx4 v40, s[32:35], s22 offen offset:0 lds
  buffer_load_dwordx4 v41, s[32:35], s22 offen offset:1024 lds
  buffer_load_dwordx4 v42, s[32:35], s22 offen offset:2048 lds
  buffer_load_dwordx4 v43, s[32:35], s22 offen offset:3072 lds
  s_add_u32 s22, s22, 147456
  s_mov_b32 m0, 32768
  s_nop 0
  buffer_load_dwordx4 v40, s[32:35], s22 offen offset:0 lds
  buffer_load_dwordx4 v41, s[32:35], s22 offen offset:1024 lds
  buffer_load_dwordx4 v42, s[32:35], s22 offen offset:2048 lds
  buffer_load_dwordx4 v43, s[32:35], s22 offen offset:3072 lds
  s_add_u32 s22, s22, 147456
  s_mov_b32 m0, 49152
  s_nop 0
  buffer_load_dwordx4 v7, s[28:31], s21 offen offset:0 sc1 lds
  buffer_load_dwordx4 v7, s[28:31], s21 offen offset:1024 sc1 lds
  buffer_load_dwordx4 v7, s[28:31], s21 offen offset:2048 sc1 lds
  buffer_load_dwordx4 v7, s[28:31], s21 offen offset:3072 sc1 lds
  s_add_u32 s21, s21, 4096
  s_mov_b32 m0, 36864
  s_nop 0
  buffer_load_dwordx4 v40, s[32:35], s22 offen offset:0 lds
  buffer_load_dwordx4 v41, s[32:35], s22 offen offset:1024 lds
  buffer_load_dwordx4 v42, s[32:35], s22 offen offset:2048 lds
  buffer_load_dwordx4 v43, s[32:35], s22 offen offset:3072 lds
  s_add_u32 s22, s22, 147456
  s_mov_b32 m0, 53248
  s_nop 0
  buffer_load_dwordx4 v7, s[28:31], s21 offen offset:0 sc1 lds
  buffer_load_dwordx4 v7, s[28:31], s21 offen offset:1024 sc1 lds
  buffer_load_dwordx4 v7, s[28:31], s21 offen offset:2048 sc1 lds
  buffer_load_dwordx4 v7, s[28:31], s21 offen offset:3072 sc1 lds
  s_add_u32 s21, s21, 65536
  s_mov_b32 m0, 40960
  s_nop 0
  buffer_load_dwordx4 v40, s[32:35], s22 offen offset:0 lds
  buffer_load_dwordx4 v41, s[32:35], s22 offen offset:1024 lds
  buffer_load_dwordx4 v42, s[32:35], s22 offen offset:2048 lds
  buffer_load_dwordx4 v43, s[32:35], s22 offen offset:3072 lds
  s_add_u32 s22, s22, 147456
  s_waitcnt vmcnt(56)
  s_barrier
  s_mov_b32 m0, 73728
  s_nop 0
  buffer_load_dwordx4 v7, s[28:31], s21 offen offset:0 sc1 lds
  buffer_load_dwordx4 v7, s[28:31], s21 offen offset:1024 sc1 lds
  buffer_load_dwordx4 v7, s[28:31], s21 offen offset:2048 sc1 lds
  buffer_load_dwordx4 v7, s[28:31], s21 offen offset:3072 sc1 lds
  s_add_u32 s21, s21, 4096
  s_mov_b32 m0, 57344
  s_nop 0
  buffer_load_dwordx4 v40, s[32:35], s22 offen offset:0 lds
  buffer_load_dwordx4 v41, s[32:35], s22 offen offset:1024 lds
  buffer_load_dwordx4 v42, s[32:35], s22 offen offset:2048 lds
  buffer_load_dwordx4 v43, s[32:35], s22 offen offset:3072 lds
  s_add_u32 s22, s22, 147456
  s_mov_b32 m0, 61440
  s_nop 0
  buffer_load_dwordx4 v40, s[32:35], s22 offen offset:0 lds
  buffer_load_dwordx4 v41, s[32:35], s22 offen offset:1024 lds
  buffer_load_dwordx4 v42, s[32:35], s22 offen offset:2048 lds
  buffer_load_dwordx4 v43, s[32:35], s22 offen offset:3072 lds
  s_add_u32 s22, s22, 147456
  s_mov_b32 m0, 77824
  s_nop 0
  buffer_load_dwordx4 v7, s[28:31], s21 offen offset:0 sc1 lds
  buffer_load_dwordx4 v7, s[28:31], s21 offen offset:1024 sc1 lds
  buffer_load_dwordx4 v7, s[28:31], s21 offen offset:2048 sc1 lds
  buffer_load_dwordx4 v7, s[28:31], s21 offen offset:3072 sc1 lds
  s_add_u32 s21, s21, 4096
  s_mov_b32 m0, 65536
  s_nop 0
  buffer_load_dwordx4 v40, s[32:35], s22 offen offset:0 lds
  buffer_load_dwordx4 v41, s[32:35], s22 offen offset:1024 lds
  buffer_load_dwordx4 v42, s[32:35], s22 offen offset:2048 lds
  buffer_load_dwordx4 v43, s[32:35], s22 offen offset:3072 lds
  s_add_u32 s22, s22, 147456
  s_mov_b32 m0, 81920
  s_nop 0
  buffer_load_dwordx4 v7, s[28:31], s21 offen offset:0 sc1 lds
  buffer_load_dwordx4 v7, s[28:31], s21 offen offset:1024 sc1 lds
  buffer_load_dwordx4 v7, s[28:31], s21 offen offset:2048 sc1 lds
  buffer_load_dwordx4 v7, s[28:31], s21 offen offset:3072 sc1 lds
  s_add_u32 s21, s21, 65536
  s_mov_b32 m0, 69632
  s_nop 0
  buffer_load_dwordx4 v40, s[32:35], s22 offen offset:0 lds
  buffer_load_dwordx4 v41, s[32:35], s22 offen offset:1024 lds
  buffer_load_dwordx4 v42, s[32:35], s22 offen offset:2048 lds
  buffer_load_dwordx4 v43, s[32:35], s22 offen offset:3072 lds
  s_add_u32 s22, s22, 147456
  s_waitcnt vmcnt(56)
  s_barrier
  s_mov_b32 m0, 102400
  s_nop 0
  buffer_load_dwordx4 v7, s[28:31], s21 offen offset:0 sc1 lds
  buffer_load_dwordx4 v7, s[28:31], s21 offen offset:1024 sc1 lds
  buffer_load_dwordx4 v7, s[28:31], s21 offen offset:2048 sc1 lds
  buffer_load_dwordx4 v7, s[28:31], s21 offen offset:3072 sc1 lds
  s_add_u32 s21, s21, 4096
  s_mov_b32 m0, 86016
  s_nop 0
  buffer_load_dwordx4 v40, s[32:35], s22 offen offset:0 lds
  buffer_load_dwordx4 v41, s[32:35], s22 offen offset:1024 lds
  buffer_load_dwordx4 v42, s[32:35], s22 offen offset:2048 lds
  buffer_load_dwordx4 v43, s[32:35], s22 offen offset:3072 lds
  s_add_u32 s22, s22, 147456
  s_mov_b32 m0, 90112
  s_nop 0
  buffer_load_dwordx4 v40, s[32:35], s22 offen offset:0 lds
  buffer_load_dwordx4 v41, s[32:35], s22 offen offset:1024 lds
  buffer_load_dwordx4 v42, s[32:35], s22 offen offset:2048 lds
  buffer_load_dwordx4 v43, s[32:35], s22 offen offset:3072 lds
  s_add_u32 s22, s22, 147456
  s_mov_b32 m0, 106496
  s_nop 0
  buffer_load_dwordx4 v7, s[28:31], s21 offen offset:0 sc1 lds
  buffer_load_dwordx4 v7, s[28:31], s21 offen offset:1024 sc1 lds
  buffer_load_dwordx4 v7, s[28:31], s21 offen offset:2048 sc1 lds
  buffer_load_dwordx4 v7, s[28:31], s21 offen offset:3072 sc1 lds
  s_add_u32 s21, s21, 4096
  s_mov_b32 m0, 94208
  s_nop 0
  buffer_load_dwordx4 v40, s[32:35], s22 offen offset:0 lds
  buffer_load_dwordx4 v41, s[32:35], s22 offen offset:1024 lds
  buffer_load_dwordx4 v42, s[32:35], s22 offen offset:2048 lds
  buffer_load_dwordx4 v43, s[32:35], s22 offen offset:3072 lds
  s_add_u32 s22, s22, 147456
  s_mov_b32 m0, 110592
  s_nop 0
  buffer_load_dwordx4 v7, s[28:31], s21 offen offset:0 sc1 lds
  buffer_load_dwordx4 v7, s[28:31], s21 offen offset:1024 sc1 lds
  buffer_load_dwordx4 v7, s[28:31], s21 offen offset:2048 sc1 lds
  buffer_load_dwordx4 v7, s[28:31], s21 offen offset:3072 sc1 lds
  s_add_u32 s21, s21, 65536
  s_mov_b32 m0, 98304
  s_nop 0
  buffer_load_dwordx4 v40, s[32:35], s22 offen offset:0 lds
  buffer_load_dwordx4 v41, s[32:35], s22 offen offset:1024 lds
  buffer_load_dwordx4 v42, s[32:35], s22 offen offset:2048 lds
  buffer_load_dwordx4 v43, s[32:35], s22 offen offset:3072 lds
  s_add_u32 s22, s22, 147456
  s_waitcnt vmcnt(56)
  s_barrier
  s_sub_u32 s25, s25, 1
  s_cmp_lg_u32 s25, 0
  s_cbranch_scc1 L_g1_lloop
  s_mov_b32 s32, s98
  s_mov_b32 s33, s99
  s_mov_b32 s34, 0x1200000
  s_mov_b32 s35, 0x20000
  s_cmp_ge_u32 s2, 192
  s_cbranch_scc1 L_m_late
  s_lshr_b32 s13, s2, 3
  s_mul_i32 s12, s13, 10923
  s_lshr_b32 s12, s12, 16
  s_mul_i32 s15, s12, 6
  s_sub_u32 s15, s13, s15
  s_bfe_u32 s19, s2, 0x10002
  s_and_b32 s13, s2, 3
  s_lshl_b32 s14, s13, 2
  s_add_u32 s14, s14, s12
  s_mul_i32 s13, s13, 9
  s_add_u32 s13, s13, 1
  s_lshr_b32 s13, s13, 1
  s_lshl_b32 s16, s14, 7
  s_lshl_b32 s17, s19, 6
  s_add_u32 s16, s16, s17
  s_mul_i32 s57, s15, 12288
  s_mul_i32 s18, s19, 2654208
  s_add_u32 s57, s57, s18
  s_lshl_b32 s56, s14, 8
  s_mul_i32 s18, s19, 9437184
  s_add_u32 s56, s56, s18
  s_mov_b32 s54, -1
  s_mov_b32 s55, -1
  s_add_u32 s54, s54, 1
  s_add_u32 s18, s54, s12
  s_and_b32 s18, s18, 3
  s_cmp_lt_u32 s54, 4
  s_cselect_b32 s18, s18, s54
  s_add_u32 s18, s18, s13
  s_cmp_ge_u32 s18, 18
  s_cselect_b32 s17, 18, 0
  s_sub_u32 s18, s18, s17
  s_mul_i32 s18, s18, 524288
  s_add_u32 s22, s18, s56
  s_add_u32 s55, s55, 1
  s_add_u32 s18, s55, s12
  s_and_b32 s18, s18, 3
  s_cmp_lt_u32 s55, 4
  s_cselect_b32 s18, s18, s55
  s_add_u32 s18, s18, s13
  s_cmp_ge_u32 s18, 18
  s_cselect_b32 s17, 18, 0
  s_sub_u32 s18, s18, s17
  s_mul_i32 s18, s18, 147456
  s_add_u32 s21, s18, s57
  v_mul_u32_u24 v4, 4096, v3
  v_lshlrev_b32 v5, 1, v3
  v_xor_b32 v5, v5, v2
  v_lshl_add_u32 v6, v5, 4, v4
  v_xor_b32 v5, 8, v5
  v_lshl_add_u32 v8, v5, 4, v4
  v_add_u32 v40, 0, v6
  v_add_u32 v41, 15360, v8
  v_add_u32 v42, 30720, v6
  v_add_u32 v43, 46080, v8
  s_add_u32 s28, s4, 0x4c0000
  s_addc_u32 s29, s5, 0
  s_mov_b32 s30, 0x510000
  s_mov_b32 s31, 0x20000
  s_mov_b32 m0, 0
  s_nop 0
  buffer_load_dwordx4 v40, s[32:35], s22 offen offset:0 lds
  buffer_load_dwordx4 v41, s[32:35], s22 offen offset:1024 lds
  buffer_load_dwordx4 v42, s[32:35], s22 offen offset:2048 lds
  buffer_load_dwordx4 v43, s[32:35], s22 offen offset:3072 lds
  s_add_u32 s22, s22, 65536
  s_mov_b32 m0, 4096
  s_nop 0
  buffer_load_dwordx4 v40, s[32:35], s22 offen offset:0 lds
  buffer_load_dwordx4 v41, s[32:35], s22 offen offset:1024 lds
  buffer_load_dwordx4 v42, s[32:35], s22 offen offset:2048 lds
  buffer_load_dwordx4 v43, s[32:35], s22 offen offset:3072 lds
  s_add_u32 s22, s22, 65536
  s_mov_b32 m0, 8192
  s_nop 0
  buffer_load_dwordx4 v40, s[32:35], s22 offen offset:0 lds
  buffer_load_dwordx4 v41, s[32:35], s22 offen offset:1024 lds
  buffer_load_dwordx4 v42, s[32:35], s22 offen offset:2048 lds
  buffer_load_dwordx4 v43, s[32:35], s22 offen offset:3072 lds
  s_add_u32 s22, s22, 65536
  s_mov_b32 m0, 12288
  s_nop 0
  buffer_load_dwordx4 v40, s[32:35], s22 offen offset:0 lds
  buffer_load_dwordx4 v41, s[32:35], s22 offen offset:1024 lds
  buffer_load_dwordx4 v42, s[32:35], s22 offen offset:2048 lds
  buffer_load_dwordx4 v43, s[32:35], s22 offen offset:3072 lds
  s_add_u32 s22, s22, 65536
  s_waitcnt vmcnt(44)
  s_barrier
  s_mov_b32 m0, 28672
  s_nop 0
  buffer_load_dwordx4 v40, s[32:35], s22 offen offset:0 lds
  buffer_load_dwordx4 v41, s[32:35], s22 offen offset:1024 lds
  buffer_load_dwordx4 v42, s[32:35], s22 offen offset:2048 lds
  buffer_load_dwordx4 v43, s[32:35], s22 offen offset:3072 lds
  s_add_u32 s22, s22, 65536
  s_mov_b32 m0, 32768
  s_nop 0
  buffer_load_dwordx4 v40, s[32:35], s22 offen offset:0 lds
  buffer_load_dwordx4 v41, s[32:35], s22 offen offset:1024 lds
  buffer_load_dwordx4 v42, s[32:35], s22 offen offset:2048 lds
  buffer_load_dwordx4 v43, s[32:35], s22 offen offset:3072 lds
  s_add_u32 s22, s22, 65536
  s_mov_b32 m0, 36864
  s_nop 0
  buffer_load_dwordx4 v40, s[32:35], s22 offen offset:0 lds
  buffer_load_dwordx4 v41, s[32:35], s22 offen offset:1024 lds
  buffer_load_dwordx4 v42, s[32:35], s22 offen offset:2048 lds
  buffer_load_dwordx4 v43, s[32:35], s22 offen offset:3072 lds
  s_add_u32 s22, s22, 65536
  s_mov_b32 m0, 40960
  s_nop 0
  buffer_load_dwordx4 v40, s[32:35], s22 offen offset:0 lds
  buffer_load_dwordx4 v41, s[32:35], s22 offen offset:1024 lds
  buffer_load_dwordx4 v42, s[32:35], s22 offen offset:2048 lds
  buffer_load_dwordx4 v43, s[32:35], s22 offen offset:3072 lds
  s_add_u32 s54, s54, 1
  s_add_u32 s18, s54, s12
  s_and_b32 s18, s18, 3
  s_cmp_lt_u32 s54, 4
  s_cselect_b32 s18, s18, s54
  s_add_u32 s18, s18, s13
  s_cmp_ge_u32 s18, 18
  s_cselect_b32 s17, 18, 0
  s_sub_u32 s18, s18, s17
  s_mul_i32 s18, s18, 524288
  s_add_u32 s22, s18, s56
  s_waitcnt vmcnt(32)
  s_barrier
  s_mov_b32 m0, 57344
  s_nop 0
  buffer_load_dwordx4 v40, s[32:35], s22 offen offset:0 lds
  buffer_load_dwordx4 v41, s[32:35], s22 offen offset:1024 lds
  buffer_load_dwordx4 v42, s[32:35], s22 offen offset:2048 lds
  buffer_load_dwordx4 v43, s[32:35], s22 offen offset:3072 lds
  s_add_u32 s22, s22, 65536
  s_mov_b32 m0, 61440
  s_nop 0
  buffer_load_dwordx4 v40, s[32:35], s22 offen offset:0 lds
  buffer_load_dwordx4 v41, s[32:35], s22 offen offset:1024 lds
  buffer_load_dwordx4 v42, s[32:35], s22 offen offset:2048 lds
  buffer_load_dwordx4 v43, s[32:35], s22 offen offset:3072 lds
  s_add_u32 s22, s22, 65536
  s_mov_b32 m0, 65536
  s_nop 0
  buffer_load_dwordx4 v40, s[32:35], s22 offen offset:0 lds
  buffer_load_dwordx4 v41, s[32:35], s22 offen offset:1024 lds
  buffer_load_dwordx4 v42, s[32:35], s22 offen offset:2048 lds
  buffer_load_dwordx4 v43, s[32:35], s22 offen offset:3072 lds
  s_add_u32 s22, s22, 65536
  s_mov_b32 m0, 69632
  s_nop 0
  buffer_load_dwordx4 v40, s[32:35], s22 offen offset:0 lds
  buffer_load_dwordx4 v41, s[32:35], s22 offen offset:1024 lds
  buffer_load_dwordx4 v42, s[32:35], s22 offen offset:2048 lds
  buffer_load_dwordx4 v43, s[32:35], s22 offen offset:3072 lds
  s_add_u32 s22, s22, 65536
  s_barrier
  s_mov_b32 m0, 86016
  s_nop 0
  buffer_load_dwordx4 v40, s[32:35], s22 offen offset:0 lds
  buffer_load_dwordx4 v41, s[32:35], s22 offen offset:1024 lds
  buffer_load_dwordx4 v42, s[32:35], s22 offen offset:2048 lds
  buffer_load_dwordx4 v43, s[32:35], s22 offen offset:3072 lds
  s_add_u32 s22, s22, 65536
  s_mov_b32 m0, 90112
  s_nop 0
  buffer_load_dwordx4 v40, s[32:35], s22 offen offset:0 lds
  buffer_load_dwordx4 v41, s[32:35], s22 offen offset:1024 lds
  buffer_load_dwordx4 v42, s[32:35], s22 offen offset:2048 lds
  buffer_load_dwordx4 v43, s[32:35], s22 offen offset:3072 lds
  s_add_u32 s22, s22, 65536
  s_mov_b32 m0, 94208
  s_nop 0
  buffer_load_dwordx4 v40, s[32:35], s22 offen offset:0 lds
  buffer_load_dwordx4 v41, s[32:35], s22 offen offset:1024 lds
  buffer_load_dwordx4 v42, s[32:35], s22 offen offset:2048 lds
  buffer_load_dwordx4 v43, s[32:35], s22 offen offset:3072 lds
  s_add_u32 s22, s22, 65536
  s_mov_b32 m0, 98304
  s_nop 0
  buffer_load_dwordx4 v40, s[32:35], s22 offen offset:0 lds
  buffer_load_dwordx4 v41, s[32:35], s22 offen offset:1024 lds
  buffer_load_dwordx4 v42, s[32:35], s22 offen offset:2048 lds
  buffer_load_dwordx4 v43, s[32:35], s22 offen offset:3072 lds
  s_add_u32 s54, s54, 1
  s_add_u32 s18, s54, s12
  s_and_b32 s18, s18, 3
  s_cmp_lt_u32 s54, 4
  s_cselect_b32 s18, s18, s54
  s_add_u32 s18, s18, s13
  s_cmp_ge_u32 s18, 18
  s_cselect_b32 s17, 18, 0
  s_sub_u32 s18, s18, s17
  s_mul_i32 s18, s18, 524288
  s_add_u32 s22, s18, s56
  v_mov_b32 v61, 0
  s_add_u32 s55, s55, 1
  s_add_u32 s18, s55, s12
  s_and_b32 s18, s18, 3
  s_cmp_lt_u32 s55, 4
  s_cselect_b32 s18, s18, s55
  s_add_u32 s18, s18, s13
  s_cmp_ge_u32 s18, 18
  s_cselect_b32 s17, 18, 0
  s_sub_u32 s18, s18, s17
  s_mul_i32 s18, s18, 147456
  s_add_u32 s21, s18, s57
  s_waitcnt vmcnt(32)
  s_barrier
  s_barrier
  s_mul_i32 s23, s15, 36
  s_mul_i32 s24, s19, 18
  s_add_u32 s23, s23, s24
  s_lshl_b32 s23, s23, 8
  s_add_u32 s23, s23, 131072
  v_and_b32 v60, 3, v1
  v_add_u32 v60, s13, v60
  v_lshlrev_b32 v60, 8, v60
  s_mov_b32 s61, 0x100000
L_l2a_poll:
  buffer_load_dword v62, v60, s[36:39], s23 offen sc1
  s_sub_u32 s61, s61, 1
  s_cbranch_scc1 L_l2a_go
  s_waitcnt vmcnt(0)
  v_cmp_ne_u32 vcc, s101, v62
  s_nop 0
  s_cmp_eq_u64 vcc, 0
  s_cbranch_scc1 L_l2a_go
  s_sleep 1
  s_branch L_l2a_poll
L_l2a_go:
  v_min_u32 v60, 17, v1
  v_lshlrev_b32 v60, 8, v60
  s_mov_b32 s53, s23
  s_mov_b32 m0, 73728
  s_nop 0
  buffer_load_dwordx4 v7, s[28:31], s21 offen offset:0 sc1 lds
  buffer_load_dwordx4 v7, s[28:31], s21 offen offset:1024 sc1 lds
  buffer_load_dwordx4 v7, s[28:31], s21 offen offset:2048 sc1 lds
  buffer_load_dwordx4 v7, s[28:31], s21 offen offset:3072 sc1 lds
  s_add_u32 s21, s21, 4096
  s_mov_b32 m0, 77824
  s_nop 0
  buffer_load_dwordx4 v7, s[28:31], s21 offen offset:0 sc1 lds
  buffer_load_dwordx4 v7, s[28:31], s21 offen offset:1024 sc1 lds
  buffer_load_dwordx4 v7, s[28:31], s21 offen offset:2048 sc1 lds
  buffer_load_dwordx4 v7, s[28:31], s21 offen offset:3072 sc1 lds
  s_add_u32 s21, s21, 4096
  s_mov_b32 m0, 81920
  s_nop 0
  buffer_load_dwordx4 v7, s[28:31], s21 offen offset:0 sc1 lds
  buffer_load_dwordx4 v7, s[28:31], s21 offen offset:1024 sc1 lds
  buffer_load_dwordx4 v7, s[28:31], s21 offen offset:2048 sc1 lds
  buffer_load_dwordx4 v7, s[28:31], s21 offen offset:3072 sc1 lds
  s_add_u32 s21, s21, 65536
  s_mov_b32 m0, 102400
  s_nop 0
  buffer_load_dwordx4 v7, s[28:31], s21 offen offset:0 sc1 lds
  buffer_load_dwordx4 v7, s[28:31], s21 offen offset:1024 sc1 lds
  buffer_load_dwordx4 v7, s[28:31], s21 offen offset:2048 sc1 lds
  buffer_load_dwordx4 v7, s[28:31], s21 offen offset:3072 sc1 lds
  s_add_u32 s21, s21, 4096
  s_mov_b32 m0, 106496
  s_nop 0
  buffer_load_dwordx4 v7, s[28:31], s21 offen offset:0 sc1 lds
  buffer_load_dwordx4 v7, s[28:31], s21 offen offset:1024 sc1 lds
  buffer_load_dwordx4 v7, s[28:31], s21 offen offset:2048 sc1 lds
  buffer_load_dwordx4 v7, s[28:31], s21 offen offset:3072 sc1 lds
  s_add_u32 s21, s21, 4096
  s_mov_b32 m0, 110592
  s_nop 0
  buffer_load_dwordx4 v7, s[28:31], s21 offen offset:0 sc1 lds
  buffer_load_dwordx4 v7, s[28:31], s21 offen offset:1024 sc1 lds
  buffer_load_dwordx4 v7, s[28:31], s21 offen offset:2048 sc1 lds
  buffer_load_dwordx4 v7, s[28:31], s21 offen offset:3072 sc1 lds
  s_add_u32 s55, s55, 1
  s_add_u32 s18, s55, s12
  s_and_b32 s18, s18, 3
  s_cmp_lt_u32 s55, 4
  s_cselect_b32 s18, s18, s55
  s_add_u32 s18, s18, s13
  s_cmp_ge_u32 s18, 18
  s_cselect_b32 s17, 18, 0
  s_sub_u32 s18, s18, s17
  s_mul_i32 s18, s18, 147456
  s_add_u32 s21, s18, s57
  s_mov_b32 s25, 8
L_g2_lloop:
  s_cmp_lg_u32 s25, 7
  s_cbranch_scc1 L_g2_no8
  v_cmp_ne_u32 vcc, s101, v63
  s_nop 0
  s_cmp_eq_u64 vcc, 0
  s_cbranch_scc1 L_l2b_go
  s_mov_b32 s61, 0x100000
L_l2b_poll:
  buffer_load_dword v62, v60, s[36:39], s53 offen sc1
  s_sub_u32 s61, s61, 1
  s_cbranch_scc1 L_l2b_go
  s_waitcnt vmcnt(0)
  v_cmp_ne_u32 vcc, s101, v62
  s_nop 0
  s_cmp_eq_u64 vcc, 0
  s_cbranch_scc1 L_l2b_go
  s_sleep 1
  s_branch L_l2b_poll
L_l2b_go:
L_g2_no8:
  s_mov_b32 m0, 16384
  s_nop 0
  buffer_load_dwordx4 v7, s[28:31], s21 offen offset:0 sc1 lds
  buffer_load_dwordx4 v7, s[28:31], s21 offen offset:1024 sc1 lds
  buffer_load_dwordx4 v7, s[28:31], s21 offen offset:2048 sc1 lds
  buffer_load_dwordx4 v7, s[28:31], s21 offen offset:3072 sc1 lds
  s_add_u32 s21, s21, 4096
  s_mov_b32 m0, 0
  s_nop 0
  buffer_load_dwordx4 v40, s[32:35], s22 offen offset:0 lds
  buffer_load_dwordx4 v41, s[32:35], s22 offen offset:1024 lds
  buffer_load_dwordx4 v42, s[32:35], s22 offen offset:2048 lds
  buffer_load_dwordx4 v43, s[32:35], s22 offen offset:3072 lds
  s_add_u32 s22, s22, 65536
  s_mov_b32 m0, 4096
  s_nop 0
  buffer_load_dwordx4 v40, s[32:35], s22 offen offset:0 lds
  buffer_load_dwordx4 v41, s[32:35], s22 offen offset:1024 lds
  buffer_load_dwordx4 v42, s[32:35], s22 offen offset:2048 lds
  buffer_load_dwordx4 v43, s[32:35], s22 offen offset:3072 lds
  s_add_u32 s22, s22, 65536
  s_mov_b32 m0, 20480
  s_nop 0
  buffer_load_dwordx4 v7, s[28:31], s21 offen offset:0 sc1 lds
  buffer_load_dwordx4 v7, s[28:31], s21 offen offset:1024 sc1 lds
  buffer_load_dwordx4 v7, s[28:31], s21 offen offset:2048 sc1 lds
  buffer_load_dwordx4 v7, s[28:31], s21 offen offset:3072 sc1 lds
  s_add_u32 s21, s21, 4096
  s_mov_b32 m0, 8192
  s_nop 0
  buffer_load_dwordx4 v40, s[32:35], s22 offen offset:0 lds
  buffer_load_dwordx4 v41, s[32:35], s22 offen offset:1024 lds
  buffer_load_dwordx4 v42, s[32:35], s22 offen offset:2048 lds
  buffer_load_dwordx4 v43, s[32:35], s22 offen offset:3072 lds
  s_add_u32 s22, s22, 65536
  s_mov_b32 m0, 24576
  s_nop 0
  buffer_load_dwordx4 v7, s[28:31], s21 offen offset:0 sc1 lds
  buffer_load_dwordx4 v7, s[28:31], s21 offen offset:1024 sc1 lds
  buffer_load_dwordx4 v7, s[28:31], s21 offen offset:2048 sc1 lds
  buffer_load_dwordx4 v7, s[28:31], s21 offen offset:3072 sc1 lds
  s_add_u32 s21, s21, 65536
  s_mov_b32 m0, 12288
  s_nop 0
  buffer_load_dwordx4 v40, s[32:35], s22 offen offset:0 lds
  buffer_load_dwordx4 v41, s[32:35], s22 offen offset:1024 lds
  buffer_load_dwordx4 v42, s[32:35], s22 offen offset:2048 lds
  buffer_load_dwordx4 v43, s[32:35], s22 offen offset:3072 lds
  s_add_u32 s22, s22, 65536
  s_cmp_lg_u32 s25, 8
  s_cbranch_scc1 L_g2_steady
  s_waitcnt vmcnt(40)
L_g2_steady:
  s_waitcnt vmcnt(56)
  s_barrier
  s_mov_b32 m0, 45056
  s_nop 0
  buffer_load_dwordx4 v7, s[28:31], s21 offen offset:0 sc1 lds
  buffer_load_dwordx4 v7, s[28:31], s21 offen offset:1024 sc1 lds
  buffer_load_dwordx4 v7, s[28:31], s21 offen offset:2048 sc1 lds
  buffer_load_dwordx4 v7, s[28:31], s21 offen offset:3072 sc1 lds
  s_add_u32 s21, s21, 4096
  s_mov_b32 m0, 28672
  s_nop 0
  buffer_load_dwordx4 v40, s[32:35], s22 offen offset:0 lds
  buffer_load_dwordx4 v41, s[32:35], s22 offen offset:1024 lds
  buffer_load_dwordx4 v42, s[32:35], s22 offen offset:2048 lds
  buffer_load_dwordx4 v43, s[32:35], s22 offen offset:3072 lds
  s_add_u32 s22, s22, 65536
  s_mov_b32 m0, 32768
  s_nop 0
  buffer_load_dwordx4 v40, s[32:35], s22 offen offset:0 lds
  buffer_load_dwordx4 v41, s[32:35], s22 offen offset:1024 lds
  buffer_load_dwordx4 v42, s[32:35], s22 offen offset:2048 lds
  buffer_load_dwordx4 v43, s[32:35], s22 offen offset:3072 lds
  s_add_u32 s22, s22, 65536
  s_mov_b32 m0, 49152
  s_nop 0
  buffer_load_dwordx4 v7, s[28:31], s21 offen offset:0 sc1 lds
  buffer_load_dwordx4 v7, s[28:31], s21 offen offset:1024 sc1 lds
  buffer_load_dwordx4 v7, s[28:31], s21 offen offset:2048 sc1 lds
  buffer_load_dwordx4 v7, s[28:31], s21 offen offset:3072 sc1 lds
  s_add_u32 s21, s21, 4096
  s_mov_b32 m0, 36864
  s_nop 0
  buffer_load_dwordx4 v40, s[32:35], s22 offen offset:0 lds
  buffer_load_dwordx4 v41, s[32:35], s22 offen offset:1024 lds
  buffer_load_dwordx4 v42, s[32:35], s22 offen offset:2048 lds
  buffer_load_dwordx4 v43, s[32:35], s22 offen offset:3072 lds
  s_add_u32 s22, s22, 65536
  s_mov_b32 m0, 53248
  s_nop 0
  buffer_load_dwordx4 v7, s[28:31], s21 offen offset:0 sc1 lds
  buffer_load_dwordx4 v7, s[28:31], s21 offen offset:1024 sc1 lds
  buffer_load_dwordx4 v7, s[28:31], s21 offen offset:2048 sc1 lds
  buffer_load_dwordx4 v7, s[28:31], s21 offen offset:3072 sc1 lds
  s_add_u32 s55, s55, 1
  s_add_u32 s18, s55, s12
  s_and_b32 s18, s18, 3
  s_cmp_lt_u32 s55, 4
  s_cselect_b32 s18, s18, s55
  s_add_u32 s18, s18, s13
  s_cmp_ge_u32 s18, 18
  s_cselect_b32 s17, 18, 0
  s_sub_u32 s18, s18, s17
  s_mul_i32 s18, s18, 147456
  s_add_u32 s21, s18, s57
  s_mov_b32 m0, 40960
  s_nop 0
  buffer_load_dwordx4 v40, s[32:35], s22 offen offset:0 lds
  buffer_load_dwordx4 v41, s[32:35], s22 offen offset:1024 lds
  buffer_load_dwordx4 v42, s[32:35], s22 offen offset:2048 lds
  buffer_load_dwordx4 v43, s[32:35], s22 offen offset:3072 lds
  s_add_u32 s54, s54, 1
  s_add_u32 s18, s54, s12
  s_and_b32 s18, s18, 3
  s_cmp_lt_u32 s54, 4
  s_cselect_b32 s18, s18, s54
  s_add_u32 s18, s18, s13
  s_cmp_ge_u32 s18, 18
  s_cselect_b32 s17, 18, 0
  s_sub_u32 s18, s18, s17
  s_mul_i32 s18, s18, 524288
  s_add_u32 s22, s18, s56
  s_waitcnt vmcnt(56)
  s_barrier
  s_cmp_lg_u32 s25, 8
  s_cbranch_scc1 L_g2_nopeek
  buffer_load_dword v63, v60, s[36:39], s53 offen sc1
L_g2_nopeek:
  s_mov_b32 m0, 73728
  s_nop 0
  buffer_load_dwordx4 v7, s[28:31], s21 offen offset:0 sc1 lds
  buffer_load_dwordx4 v7, s[28:31], s21 offen offset:1024 sc1 lds
  buffer_load_dwordx4 v7, s[28:31], s21 offen offset:2048 sc1 lds
  buffer_load_dwordx4 v7, s[28:31], s21 offen offset:3072 sc1 lds
  s_add_u32 s21, s21, 4096
  s_mov_b32 m0, 57344
  s_nop 0
  buffer_load_dwordx4 v40, s[32:35], s22 offen offset:0 lds
  buffer_load_dwordx4 v41, s[32:35], s22 offen offset:1024 lds
  buffer_load_dwordx4 v42, s[32:35], s22 offen offset:2048 lds
  buffer_load_dwordx4 v43, s[32:35], s22 offen offset:3072 lds
  s_add_u32 s22, s22, 65536
  s_mov_b32 m0, 61440
  s_nop 0
  buffer_load_dwordx4 v40, s[32:35], s22 offen offset:0 lds
  buffer_load_dwordx4 v41, s[32:35], s22 offen offset:1024 lds
  buffer_load_dwordx4 v42, s[32:35], s22 offen offset:2048 lds
  buffer_load_dwordx4 v43, s[32:35], s22 offen offset:3072 lds
  s_add_u32 s22, s22, 65536
  s_mov_b32 m0, 77824
  s_nop 0
  buffer_load_dwordx4 v7, s[28:31], s21 offen offset:0 sc1 lds
  buffer_load_dwordx4 v7, s[28:31], s21 offen offset:1024 sc1 lds
  buffer_load_dwordx4 v7, s[28:31], s21 offen offset:2048 sc1 lds
  buffer_load_dwordx4 v7, s[28:31], s21 offen offset:3072 sc1 lds
  s_add_u32 s21, s21, 4096
  s_mov_b32 m0, 65536
  s_nop 0
  buffer_load_dwordx4 v40, s[32:35], s22 offen offset:0 lds
  buffer_load_dwordx4 v41, s[32:35], s22 offen offset:1024 lds
  buffer_load_dwordx4 v42, s[32:35], s22 offen offset:2048 lds
  buffer_load_dwordx4 v43, s[32:35], s22 offen offset:3072 lds
  s_add_u32 s22, s22, 65536
  s_mov_b32 m0, 81920
  s_nop 0
  buffer_load_dwordx4 v7, s[28:31], s21 offen offset:0 sc1 lds
  buffer_load_dwordx4 v7, s[28:31], s21 offen offset:1024 sc1 lds
  buffer_load_dwordx4 v7, s[28:31], s21 offen offset:2048 sc1 lds
  buffer_load_dwordx4 v7, s[28:31], s21 offen offset:3072 sc1 lds
  s_add_u32 s21, s21, 65536
  s_mov_b32 m0, 69632
  s_nop 0
  buffer_load_dwordx4 v40, s[32:35], s22 offen offset:0 lds
  buffer_load_dwordx4 v41, s[32:35], s22 offen offset:1024 lds
  buffer_load_dwordx4 v42, s[32:35], s22 offen offset:2048 lds
  buffer_load_dwordx4 v43, s[32:35], s22 offen offset:3072 lds
  s_add_u32 s22, s22, 65536
  s_waitcnt vmcnt(56)
  s_barrier
  s_mov_b32 m0, 102400
  s_nop 0
  buffer_load_dwordx4 v7, s[28:31], s21 offen offset:0 sc1 lds
  buffer_load_dwordx4 v7, s[28:31], s21 offen offset:1024 sc1 lds
  buffer_load_dwordx4 v7, s[28:31], s21 offen offset:2048 sc1 lds
  buffer_load_dwordx4 v7, s[28:31], s21 offen offset:3072 sc1 lds
  s_add_u32 s21, s21, 4096
  s_mov_b32 m0, 86016
  s_nop 0
  buffer_load_dwordx4 v40, s[32:35], s22 offen offset:0 lds
  buffer_load_dwordx4 v41, s[32:35], s22 offen offset:1024 lds
  buffer_load_dwordx4 v42, s[32:35], s22 offen offset:2048 lds
  buffer_load_dwordx4 v43, s[32:35], s22 offen offset:3072 lds
  s_add_u32 s22, s22, 65536
  s_mov_b32 m0, 90112
  s_nop 0
  buffer_load_dwordx4 v40, s[32:35], s22 offen offset:0 lds
  buffer_load_dwordx4 v41, s[32:35], s22 offen offset:1024 lds
  buffer_load_dwordx4 v42, s[32:35], s22 offen offset:2048 lds
  buffer_load_dwordx4 v43, s[32:35], s22 offen offset:3072 lds
  s_add_u32 s22, s22, 65536
  s_mov_b32 m0, 106496
  s_nop 0
  buffer_load_dwordx4 v7, s[28:31], s21 offen offset:0 sc1 lds
  buffer_load_dwordx4 v7, s[28:31], s21 offen offset:1024 sc1 lds
  buffer_load_dwordx4 v7, s[28:31], s21 offen offset:2048 sc1 lds
  buffer_load_dwordx4 v7, s[28:31], s21 offen offset:3072 sc1 lds
  s_add_u32 s21, s21, 4096
  s_mov_b32 m0, 94208
  s_nop 0
  buffer_load_dwordx4 v40, s[32:35], s22 offen offset:0 lds
  buffer_load_dwordx4 v41, s[32:35], s22 offen offset:1024 lds
  buffer_load_dwordx4 v42, s[32:35], s22 offen offset:2048 lds
  buffer_load_dwordx4 v43, s[32:35], s22 offen offset:3072 lds
  s_add_u32 s22, s22, 65536
  s_mov_b32 m0, 110592
  s_nop 0
  buffer_load_dwordx4 v7, s[28:31], s21 offen offset:0 sc1 lds
  buffer_load_dwordx4 v7, s[28:31], s21 offen offset:1024 sc1 lds
  buffer_load_dwordx4 v7, s[28:31], s21 offen offset:2048 sc1 lds
  buffer_load_dwordx4 v7, s[28:31], s21 offen offset:3072 sc1 lds
  s_add_u32 s55, s55, 1
  s_add_u32 s18, s55, s12
  s_and_b32 s18, s18, 3
  s_cmp_lt_u32 s55, 4
  s_cselect_b32 s18, s18, s55
  s_add_u32 s18, s18, s13
  s_cmp_ge_u32 s18, 18
  s_cselect_b32 s17, 18, 0
  s_sub_u32 s18, s18, s17
  s_mul_i32 s18, s18, 147456
  s_add_u32 s21, s18, s57
  s_mov_b32 m0, 98304
  s_nop 0
  buffer_load_dwordx4 v40, s[32:35], s22 offen offset:0 lds
  buffer_load_dwordx4 v41, s[32:35], s22 offen offset:1024 lds
  buffer_load_dwordx4 v42, s[32:35], s22 offen offset:2048 lds
  buffer_load_dwordx4 v43, s[32:35], s22 offen offset:3072 lds
  s_add_u32 s54, s54, 1
  s_add_u32 s18, s54, s12
  s_and_b32 s18, s18, 3
  s_cmp_lt_u32 s54, 4
  s_cselect_b32 s18, s18, s54
  s_add_u32 s18, s18, s13
  s_cmp_ge_u32 s18, 18
  s_cselect_b32 s17, 18, 0
  s_sub_u32 s18, s18, s17
  s_mul_i32 s18, s18, 524288
  s_add_u32 s22, s18, s56
  s_waitcnt vmcnt(56)
  s_barrier
  s_sub_u32 s25, s25, 1
  s_cmp_lg_u32 s25, 0
  s_cbranch_scc1 L_g2_lloop
  s_waitcnt vmcnt(28)
  s_barrier
  s_add_u32 s48, s4, 0x9d0000
  s_addc_u32 s49, s5, 0
  s_mov_b32 s50, 0x240000
  s_mov_b32 s51, 0x20000
  s_lshl_b32 s23, s15, 8
  s_add_u32 s23, s23, 7168
  buffer_load_dword v62, v61, s[36:39], s23 offen sc1
  v_lshrrev_b32 v8, 3, v1
  v_lshlrev_b32 v8, 12, v8
  v_and_b32 v9, 7, v1
  v_lshl_add_u32 v8, v9, 4, v8
  s_mul_i32 s26, s15, 393216
  s_lshl_b32 s27, s16, 1
  s_add_u32 s26, s26, s27
  s_cmp_eq_u32 s15, 5
  s_cselect_b32 s24, 96, 32
  s_waitcnt vmcnt(0)
  v_readfirstlane_b32 s27, v62
  s_nop 0
  s_cmp_lg_u32 s27, s24
  s_cbranch_scc1 L_at_skip
  s_mov_b32 m0, 114688
  s_nop 0
  buffer_load_dwordx4 v8, s[48:51], s26 offen sc1 lds
  s_add_u32 s26, s26, 32768
  s_mov_b32 m0, 115712
  s_nop 0
  buffer_load_dwordx4 v8, s[48:51], s26 offen sc1 lds
  s_add_u32 s26, s26, 32768
  s_mov_b32 m0, 116736
  s_nop 0
  buffer_load_dwordx4 v8, s[48:51], s26 offen sc1 lds
  s_add_u32 s26, s26, 32768
  s_mov_b32 m0, 117760
  s_nop 0
  buffer_load_dwordx4 v8, s[48:51], s26 offen sc1 lds
  s_add_u32 s26, s26, 32768
  s_mov_b32 m0, 118784
  s_nop 0
  buffer_load_dwordx4 v8, s[48:51], s26 offen sc1 lds
  s_add_u32 s26, s26, 32768
  s_mov_b32 m0, 119808
  s_nop 0
  buffer_load_dwordx4 v8, s[48:51], s26 offen sc1 lds
  s_add_u32 s26, s26, 32768
  s_mov_b32 m0, 120832
  s_nop 0
  buffer_load_dwordx4 v8, s[48:51], s26 offen sc1 lds
  s_add_u32 s26, s26, 32768
  s_mov_b32 m0, 121856
  s_nop 0
  buffer_load_dwordx4 v8, s[48:51], s26 offen sc1 lds
  s_add_u32 s26, s26, 32768
  s_mov_b32 m0, 122880
  s_nop 0
  buffer_load_dwordx4 v8, s[48:51], s26 offen sc1 lds
  s_add_u32 s26, s26, 32768
  s_mov_b32 m0, 123904
  s_nop 0
  buffer_load_dwordx4 v8, s[48:51], s26 offen sc1 lds
  s_add_u32 s26, s26, 32768
  s_mov_b32 m0, 124928
  s_nop 0
  buffer_load_dwordx4 v8, s[48:51], s26 offen sc1 lds
  s_add_u32 s26, s26, 32768
  s_mov_b32 m0, 125952
  s_nop 0
  buffer_load_dwordx4 v8, s[48:51], s26 offen sc1 lds
  s_add_u32 s26, s26, 32768
L_at_skip:
  s_barrier
  s_cmp_lg_u32 s27, s24
  s_cbranch_scc1 L_at_late
  s_waitcnt vmcnt(0)
  s_barrier
  s_endpgm
L_at_late:
  s_mov_b32 s61, 0x100000
L_at_poll:
  buffer_load_dword v62, v61, s[36:39], s23 offen sc1
  s_sub_u32 s61, s61, 1
  s_cbranch_scc1 L_at_go
  s_waitcnt vmcnt(0)
  v_cmp_ne_u32 vcc, s24, v62
  s_nop 0
  s_cmp_eq_u64 vcc, 0
  s_cbranch_scc1 L_at_go
  s_sleep 1
  s_branch L_at_poll
L_at_go:
  s_mov_b32 m0, 114688
  s_nop 0
  buffer_load_dwordx4 v8, s[48:51], s26 offen sc1 lds
  s_add_u32 s26, s26, 32768
  s_mov_b32 m0, 115712
  s_nop 0
  buffer_load_dwordx4 v8, s[48:51], s26 offen sc1 lds
  s_add_u32 s26, s26, 32768
  s_mov_b32 m0, 116736
  s_nop 0
  buffer_load_dwordx4 v8, s[48:51], s26 offen sc1 lds
  s_add_u32 s26, s26, 32768
  s_mov_b32 m0, 117760
  s_nop 0
  buffer_load_dwordx4 v8, s[48:51], s26 offen sc1 lds
  s_add_u32 s26, s26, 32768
  s_mov_b32 m0, 118784
  s_nop 0
  buffer_load_dwordx4 v8, s[48:51], s26 offen sc1 lds
  s_add_u32 s26, s26, 32768
  s_mov_b32 m0, 119808
  s_nop 0
  buffer_load_dwordx4 v8, s[48:51], s26 offen sc1 lds
  s_add_u32 s26, s26, 32768
  s_mov_b32 m0, 120832
  s_nop 0
  buffer_load_dwordx4 v8, s[48:51], s26 offen sc1 lds
  s_add_u32 s26, s26, 32768
  s_mov_b32 m0, 121856
  s_nop 0
  buffer_load_dwordx4 v8, s[48:51], s26 offen sc1 lds
  s_add_u32 s26, s26, 32768
  s_mov_b32 m0, 122880
  s_nop 0
  buffer_load_dwordx4 v8, s[48:51], s26 offen sc1 lds
  s_add_u32 s26, s26, 32768
  s_mov_b32 m0, 123904
  s_nop 0
  buffer_load_dwordx4 v8, s[48:51], s26 offen sc1 lds
  s_add_u32 s26, s26, 32768
  s_mov_b32 m0, 124928
  s_nop 0
  buffer_load_dwordx4 v8, s[48:51], s26 offen sc1 lds
  s_add_u32 s26, s26, 32768
  s_mov_b32 m0, 125952
  s_nop 0
  buffer_load_dwordx4 v8, s[48:51], s26 offen sc1 lds
  s_add_u32 s26, s26, 32768
  s_waitcnt vmcnt(0)
  s_barrier
  s_endpgm
L_m_late:
  s_waitcnt vmcnt(28)
  s_barrier
  s_waitcnt vmcnt(0)
  s_barrier
  s_barrier
  s_sub_u32 s30, s2, 152
  s_lshr_b32 s30, s30, 3
  v_mov_b32 v58, 158728
L_lw3:
  s_sleep 2
  ds_read_b32 v60, v58
  s_waitcnt lgkmcnt(0)
  v_readfirstlane_b32 s23, v60
  s_nop 0
  s_cmp_lt_u32 s23, 4
  s_cbranch_scc1 L_lw3
  v_and_b32 v1, 63, v0
  v_lshlrev_b32 v30, 4, v1
  s_and_b32 s41, s2, 3
  s_lshl_b32 s42, s41, 10
  s_mul_i32 s41, s41, 9
  s_add_u32 s41, s41, 1
  s_lshr_b32 s41, s41, 1
  s_lshl_b32 s41, s41, 7
  s_add_u32 s41, s41, s30
  s_add_u32 s41, s41, 512
  s_cmp_ge_u32 s41, 2304
  s_cselect_b32 s43, 2304, 0
  s_sub_u32 s41, s41, s43
  s_lshl_b32 s41, s41, 12
  s_bfe_u32 s43, s2, 0x10002
  s_mul_i32 s43, s43, 9437184
  s_add_u32 s42, s42, s43
  s_add_u32 s40, s41, s42
  s_add_u32 s42, s42, 9437184
  s_mov_b32 s44, 56
L_m3_pw2:
  buffer_load_dwordx4 v[64:67], v30, s[32:35], s40 offen
  s_add_u32 s40, s40, 32768
  s_cmp_ge_u32 s40, s42
  s_cselect_b32 s43, 9437184, 0
  s_sub_u32 s40, s40, s43
  buffer_load_dwordx4 v[68:71], v30, s[32:35], s40 offen
  s_add_u32 s40, s40, 32768
  s_cmp_ge_u32 s40, s42
  s_cselect_b32 s43, 9437184, 0
  s_sub_u32 s40, s40, s43
  buffer_load_dwordx4 v[72:75], v30, s[32:35], s40 offen
  s_add_u32 s40, s40, 32768
  s_cmp_ge_u32 s40, s42
  s_cselect_b32 s43, 9437184, 0
  s_sub_u32 s40, s40, s43
  buffer_load_dwordx4 v[76:79], v30, s[32:35], s40 offen
  s_add_u32 s40, s40, 32768
  s_cmp_ge_u32 s40, s42
  s_cselect_b32 s43, 9437184, 0
  s_sub_u32 s40, s40, s43
  s_waitcnt vmcnt(56)
  s_sub_u32 s44, s44, 1
  s_cmp_lg_u32 s44, 0
  s_cbranch_scc1 L_m3_pw2
  s_mov_b32 s8, s6
  s_mov_b32 s9, s7
  s_mov_b32 s10, 0x240000
  s_mov_b32 s11, 0x20000
  v_and_b32 v1, 63, v0
  v_lshlrev_b32 v30, 4, v1
  s_and_b32 s40, s2, 3
  s_lshl_b32 s40, s40, 2
  s_lshr_b32 s41, s30, 1
  s_add_u32 s40, s40, s41
  s_lshl_b32 s40, s40, 7
  s_bfe_u32 s41, s2, 0x10002
  s_lshl_b32 s41, s41, 6
  s_add_u32 s40, s40, s41
  s_and_b32 s41, s30, 1
  s_lshl_b32 s41, s41, 5
  s_add_u32 s40, s40, s41
  s_mul_i32 s40, s40, 1152
  s_mov_b32 s44, 9
L_x3_px:
  buffer_load_dwordx4 v[64:67], v30, s[8:11], s40 offen offset:0
  buffer_load_dwordx4 v[68:71], v30, s[8:11], s40 offen offset:1024
  buffer_load_dwordx4 v[72:75], v30, s[8:11], s40 offen offset:2048
  buffer_load_dwordx4 v[76:79], v30, s[8:11], s40 offen offset:3072
  s_add_u32 s40, s40, 4096
  s_sub_u32 s44, s44, 1
  s_cmp_lg_u32 s44, 0
  s_cbranch_scc1 L_x3_px
  s_endpgm
L_m_helper:
  s_sub_u32 s30, s2, 216
  s_lshr_b32 s30, s30, 3
  v_mov_b32 v58, 158724
L_lw2:
  s_sleep 2
  ds_read_b32 v60, v58
  s_waitcnt lgkmcnt(0)
  v_readfirstlane_b32 s23, v60
  s_nop 0
  s_cmp_lt_u32 s23, 4
  s_cbranch_scc1 L_lw2
  s_cmp_lg_u32 s30, 0
  s_cbranch_scc1 L_m_st0
  s_add_u32 s8, s96, 0x600000
  s_addc_u32 s9, s97, 0
  s_load_dword s12, s[8:9], 0
  s_add_u32 s8, s96, 0x1000000
  s_addc_u32 s9, s97, 0
  s_load_dword s13, s[8:9], 0
  s_add_u32 s8, s86, 0x0
  s_addc_u32 s9, s87, 0
  s_load_dword s14, s[8:9], 0
  s_add_u32 s8, s4, 0xa00000
  s_addc_u32 s9, s5, 0
  s_load_dword s15, s[8:9], 0
  s_add_u32 s8, s98, 0x400000
  s_addc_u32 s9, s99, 0
  s_load_dword s16, s[8:9], 0
  s_add_u32 s8, s98, 0xe00000
  s_addc_u32 s9, s99, 0
  s_load_dword s17, s[8:9], 0
  s_add_u32 s8, s58, 0x0
  s_addc_u32 s9, s59, 0
  s_load_dword s18, s[8:9], 0
L_m_st0:
  s_cmp_lg_u32 s30, 1
  s_cbranch_scc1 L_m_st1
  s_add_u32 s8, s96, 0x800000
  s_addc_u32 s9, s97, 0
  s_load_dword s12, s[8:9], 0
  s_add_u32 s8, s96, 0x11ffffc
  s_addc_u32 s9, s97, 0
  s_load_dword s13, s[8:9], 0
  s_add_u32 s8, s52, 0x0
  s_addc_u32 s9, s53, 0
  s_load_dword s14, s[8:9], 0
  s_add_u32 s8, s4, 0xc00000
  s_addc_u32 s9, s5, 0
  s_load_dword s15, s[8:9], 0
  s_add_u32 s8, s98, 0x600000
  s_addc_u32 s9, s99, 0
  s_load_dword s16, s[8:9], 0
  s_add_u32 s8, s98, 0x1000000
  s_addc_u32 s9, s99, 0
  s_load_dword s17, s[8:9], 0
L_m_st1:
  s_cmp_lg_u32 s30, 2
  s_cbranch_scc1 L_m_st2
  s_add_u32 s8, s96, 0xa00000
  s_addc_u32 s9, s97, 0
  s_load_dword s12, s[8:9], 0
  s_add_u32 s8, s80, 0x0
  s_addc_u32 s9, s81, 0
  s_load_dword s13, s[8:9], 0
  s_add_u32 s8, s54, 0x0
  s_addc_u32 s9, s55, 0
  s_load_dword s14, s[8:9], 0
  s_add_u32 s8, s4, 0xe00000
  s_addc_u32 s9, s5, 0
  s_load_dword s15, s[8:9], 0
  s_add_u32 s8, s98, 0x800000
  s_addc_u32 s9, s99, 0
  s_load_dword s16, s[8:9], 0
  s_add_u32 s8, s98, 0x11ffffc
  s_addc_u32 s9, s99, 0
  s_load_dword s17, s[8:9], 0
L_m_st2:
  s_cmp_lg_u32 s30, 3
  s_cbranch_scc1 L_m_st3
  s_add_u32 s8, s96, 0xc00000
  s_addc_u32 s9, s97, 0
  s_load_dword s12, s[8:9], 0
  s_add_u32 s8, s82, 0x0
  s_addc_u32 s9, s83, 0
  s_load_dword s13, s[8:9], 0
  s_add_u32 s8, s4, 0x600000
  s_addc_u32 s9, s5, 0
  s_load_dword s14, s[8:9], 0
  s_add_u32 s8, s98, 0x0
  s_addc_u32 s9, s99, 0
  s_load_dword s15, s[8:9], 0
  s_add_u32 s8, s98, 0xa00000
  s_addc_u32 s9, s99, 0
  s_load_dword s16, s[8:9], 0
  s_add_u32 s8, s48, 0x0
  s_addc_u32 s9, s49, 0
  s_load_dword s17, s[8:9], 0
L_m_st3:
  s_cmp_lg_u32 s30, 4
  s_cbranch_scc1 L_m_st4
  s_add_u32 s8, s96, 0xe00000
  s_addc_u32 s9, s97, 0
  s_load_dword s12, s[8:9], 0
  s_add_u32 s8, s84, 0x0
  s_addc_u32 s9, s85, 0
  s_load_dword s13, s[8:9], 0
  s_add_u32 s8, s4, 0x800000
  s_addc_u32 s9, s5, 0
  s_load_dword s14, s[8:9], 0
  s_add_u32 s8, s98, 0x200000
  s_addc_u32 s9, s99, 0
  s_load_dword s15, s[8:9], 0
  s_add_u32 s8, s98, 0xc00000
  s_addc_u32 s9, s99, 0
  s_load_dword s16, s[8:9], 0
  s_add_u32 s8, s48, 0x23fffc
  s_addc_u32 s9, s49, 0
  s_load_dword s17, s[8:9], 0
L_m_st4:
  v_and_b32 v1, 63, v0
  v_lshrrev_b32 v30, 4, v1
  v_mul_u32_u24 v30, 9216, v30
  v_and_b32 v31, 15, v1
  v_lshl_add_u32 v30, v31, 4, v30
  s_and_b32 s42, s2, 1
  s_and_b32 s40, s2, 7
  s_mul_i32 s40, s40, 9
  s_add_u32 s40, s40, 1
  s_lshr_b32 s40, s40, 1
  s_lshl_b32 s40, s40, 8
  s_mul_i32 s41, s30, 36864
  s_add_u32 s40, s40, s41
  s_add_u32 s40, s40, 5898240
  s_mul_i32 s43, s42, 1280
  s_sub_u32 s43, 1024, s43
  s_add_u32 s42, s42, s30
  s_mov_b32 s44, 71
  s_and_b32 s45, s2, 6
  s_cmp_eq_u32 s45, 2
  s_cselect_b32 s45, 1, 0
L_m1_pw1:
  buffer_load_dwordx4 v[64:67], v30, s[32:35], s40 offen offset:0
  buffer_load_dwordx4 v[68:71], v30, s[32:35], s40 offen offset:256
  buffer_load_dwordx4 v[72:75], v30, s[32:35], s40 offen offset:512
  buffer_load_dwordx4 v[76:79], v30, s[32:35], s40 offen offset:768
  s_and_b32 s41, s42, s45
  s_cbranch_scc1 L_m1_sk1
  s_add_u32 s41, s40, s43
  buffer_load_dwordx4 v[80:83], v30, s[32:35], s41 offen
L_m1_sk1:
  s_add_u32 s42, s42, 5
  s_add_u32 s40, s40, 184320
  s_waitcnt vmcnt(56)
  s_sub_u32 s44, s44, 1
  s_cmp_lg_u32 s44, 0
  s_cbranch_scc1 L_m1_pw1
  s_mov_b32 s32, s98
  s_mov_b32 s33, s99
  s_mov_b32 s34, 0x1200000
  s_mov_b32 s35, 0x20000
  v_and_b32 v1, 63, v0
  v_lshrrev_b32 v31, 4, v1
  v_lshlrev_b32 v31, 7, v31
  v_lshlrev_b32 v29, 4, v1
  v_add_u32 v31, s30, v31
  s_mov_b32 s45, 0
  s_and_b32 s41, s2, 3
  s_lshl_b32 s42, s41, 10
  s_mul_i32 s41, s41, 9
  s_add_u32 s41, s41, 1
  s_lshr_b32 s41, s41, 1
  s_lshl_b32 s41, s41, 7
  s_add_u32 s41, s41, s45
  s_add_u32 s41, s41, 0
  s_cmp_ge_u32 s41, 2304
  s_cselect_b32 s43, 2304, 0
  s_sub_u32 s41, s41, s43
  s_lshl_b32 s41, s41, 12
  s_bfe_u32 s43, s2, 0x10002
  s_mul_i32 s43, s43, 9437184
  s_add_u32 s42, s42, s43
  s_add_u32 s40, s41, s42
  s_add_u32 s42, s42, 9437184
  s_mov_b32 s44, 26
L_mh_ph:
  v_lshl_add_u32 v30, v31, 12, v29
  v_add_u32 v31, 5, v31
  buffer_load_dwordx4 v[64:67], v30, s[32:35], s40 offen
  v_and_b32 v31, 511, v31
  v_lshl_add_u32 v30, v31, 12, v29
  v_add_u32 v31, 5, v31
  buffer_load_dwordx4 v[68:71], v30, s[32:35], s40 offen
  v_and_b32 v31, 511, v31
  v_lshl_add_u32 v30, v31, 12, v29
  v_add_u32 v31, 5, v31
  buffer_load_dwordx4 v[72:75], v30, s[32:35], s40 offen
  v_and_b32 v31, 511, v31
  v_lshl_add_u32 v30, v31, 12, v29
  v_add_u32 v31, 5, v31
  buffer_load_dwordx4 v[76:79], v30, s[32:35], s40 offen
  v_and_b32 v31, 511, v31
  s_waitcnt vmcnt(56)
  s_sub_u32 s44, s44, 1
  s_cmp_lg_u32 s44, 0
  s_cbranch_scc1 L_mh_ph
  v_and_b32 v1, 63, v0
  v_lshlrev_b32 v30, 4, v1
  s_and_b32 s41, s2, 3
  s_lshl_b32 s42, s41, 10
  s_mul_i32 s41, s41, 9
  s_add_u32 s41, s41, 1
  s_lshr_b32 s41, s41, 1
  s_lshl_b32 s41, s41, 7
  s_add_u32 s41, s41, s30
  s_add_u32 s41, s41, 512
  s_cmp_ge_u32 s41, 2304
  s_cselect_b32 s43, 2304, 0
  s_sub_u32 s41, s41, s43
  s_lshl_b32 s41, s41, 12
  s_bfe_u32 s43, s2, 0x10002
  s_mul_i32 s43, s43, 9437184
  s_add_u32 s42, s42, s43
  s_add_u32 s40, s41, s42
  s_add_u32 s42, s42, 9437184
  s_mov_b32 s44, 56
L_m4_pw2:
  buffer_load_dwordx4 v[64:67], v30, s[32:35], s40 offen
  s_add_u32 s40, s40, 32768
  s_cmp_ge_u32 s40, s42
  s_cselect_b32 s43, 9437184, 0
  s_sub_u32 s40, s40, s43
  buffer_load_dwordx4 v[68:71], v30, s[32:35], s40 offen
  s_add_u32 s40, s40, 32768
  s_cmp_ge_u32 s40, s42
  s_cselect_b32 s43, 9437184, 0
  s_sub_u32 s40, s40, s43
  buffer_load_dwordx4 v[72:75], v30, s[32:35], s40 offen
  s_add_u32 s40, s40, 32768
  s_cmp_ge_u32 s40, s42
  s_cselect_b32 s43, 9437184, 0
  s_sub_u32 s40, s40, s43
  buffer_load_dwordx4 v[76:79], v30, s[32:35], s40 offen
  s_add_u32 s40, s40, 32768
  s_cmp_ge_u32 s40, s42
  s_cselect_b32 s43, 9437184, 0
  s_sub_u32 s40, s40, s43
  s_waitcnt vmcnt(56)
  s_sub_u32 s44, s44, 1
  s_cmp_lg_u32 s44, 0
  s_cbranch_scc1 L_m4_pw2
  s_mov_b32 s8, s6
  s_mov_b32 s9, s7
  s_mov_b32 s10, 0x240000
  s_mov_b32 s11, 0x20000
  v_and_b32 v1, 63, v0
  v_lshlrev_b32 v30, 4, v1
  s_and_b32 s40, s2, 3
  s_lshl_b32 s40, s40, 2
  s_lshr_b32 s41, s30, 1
  s_add_u32 s40, s40, s41
  s_lshl_b32 s40, s40, 7
  s_bfe_u32 s41, s2, 0x10002
  s_lshl_b32 s41, s41, 6
  s_add_u32 s40, s40, s41
  s_and_b32 s41, s30, 1
  s_lshl_b32 s41, s41, 5
  s_add_u32 s40, s40, s41
  s_mul_i32 s40, s40, 1152
  s_mov_b32 s44, 9
L_x4_px:
  buffer_load_dwordx4 v[64:67], v30, s[8:11], s40 offen offset:0
  buffer_load_dwordx4 v[68:71], v30, s[8:11], s40 offen offset:1024
  buffer_load_dwordx4 v[72:75], v30, s[8:11], s40 offen offset:2048
  buffer_load_dwordx4 v[76:79], v30, s[8:11], s40 offen offset:3072
  s_add_u32 s40, s40, 4096
  s_sub_u32 s44, s44, 1
  s_cmp_lg_u32 s44, 0
  s_cbranch_scc1 L_x4_px
  s_mov_b32 s8, s58
  s_mov_b32 s9, s59
  s_mov_b32 s10, 0x1000
  s_mov_b32 s11, 0x20000
  v_lshlrev_b32 v5, 7, v1
  buffer_load_dword v107, v5, s[8:11], 0 offen
L_m_end:
  s_endpgm
L_m_last:
.section .rodata,"a"
.p2align 6
.amdhsa_kernel parallel_sum__ssm_conv_s4d__mixer_token_mlp__prompt_kernel
  .amdhsa_next_free_vgpr 256
  .amdhsa_next_free_sgpr 102
  .amdhsa_accum_offset 256
  .amdhsa_group_segment_fixed_size 0
  .amdhsa_kernarg_size 120
  .amdhsa_user_sgpr_count 2
  .amdhsa_user_sgpr_kernarg_segment_ptr 1
  .amdhsa_system_sgpr_workgroup_id_x 1
.end_amdhsa_kernel
```
